```python
import torch

def _softmax(x, axis=-1):
    return torch.softmax(x, dim=axis)
def _gelu(x):
    return torch.nn.functional.gelu(x, approximate="tanh")
def _silu(x):
    return torch.nn.functional.silu(x)
def _sigmoid(x):
    return torch.sigmoid(x)
def _layernorm(x, axis=-1, eps=1e-5):
    m = x.mean(dim=axis, keepdim=True)
    v = x.var(dim=axis, keepdim=True, unbiased=False)
    return (x - m) / torch.sqrt(v + eps)
def _scatter_add(tgt, idx, src, axis=0):
    return tgt.clone().index_add_(axis, idx, src)
def _segment_sum(src, seg, n):
    out = torch.zeros((n,) + src.shape[1:], dtype=src.dtype)
    return out.index_add_(0, seg, src)
def _pad(x, pw):
    flat = tuple(v for pair in reversed(pw) for v in pair)
    return torch.nn.functional.pad(x, flat)

kernel_name = 'sequential_preLN__spectral_fnet__moe_arch_mod__prompt'

def setup_inputs():

    _w = (lambda a: (lambda t: t.to(torch.bfloat16) if t.is_floating_point() else t)(torch.as_tensor(a)))
    def _A_setup():
        B, S, D = 1, 2048, 576
        ns = torch.arange(S)[:, None] * torch.arange(S)[None, :]
        nd = torch.arange(D)[:, None] * torch.arange(D)[None, :]
        Ws_re = torch.cos(-2.0 * torch.pi * ns / S).to(float)
        Ws_im = torch.sin(-2.0 * torch.pi * ns / S).to(float)
        Wd_re = torch.cos(-2.0 * torch.pi * nd / D).to(float)
        Wd_im = torch.sin(-2.0 * torch.pi * nd / D).to(float)
        return {
            "x": _w((lambda *s: torch.randn(*s, dtype=torch.bfloat16) * 0.05)(B, S, D)),
            "dft_seq_re": _w(Ws_re),
            "dft_seq_im": _w(Ws_im),
            "dft_hid_re": _w(Wd_re),
            "dft_hid_im": _w(Wd_im),
        }
    _A_in = _A_setup()

    def _B_setup():
        B, S, D, F, C = 1, 2048, 576, 4608, 1
        return {
            "x": _w((lambda *s: torch.randn(*s, dtype=torch.bfloat16) * 0.05)(B, S, D)),
            "w_r": _w((lambda *s: torch.randn(*s, dtype=torch.bfloat16) * 1.6)(D)),
            "w_gate": _w((lambda *s: torch.randn(*s, dtype=torch.bfloat16) * 0.4)(D, F)),
            "w_up": _w((lambda *s: torch.randn(*s, dtype=torch.bfloat16) * 0.4)(D, F)),
            "w_down": _w((lambda *s: torch.randn(*s, dtype=torch.bfloat16) * 0.4)(F, D)),
        }
    _B_in = _B_setup()

    return {
        "A_x": _A_in["x"],
        "A_dft_seq_re": _A_in["dft_seq_re"],
        "A_dft_seq_im": _A_in["dft_seq_im"],
        "A_dft_hid_re": _A_in["dft_hid_re"],
        "A_dft_hid_im": _A_in["dft_hid_im"],
        "B_x": _B_in["x"],
        "B_w_r": _B_in["w_r"],
        "B_w_gate": _B_in["w_gate"],
        "B_w_up": _B_in["w_up"],
        "B_w_down": _B_in["w_down"],
    }

def reference(A_x, A_dft_seq_re, A_dft_seq_im, A_dft_hid_re, A_dft_hid_im, B_x, B_w_r, B_w_gate, B_w_up, B_w_down):
    def _A_ref(x, dft_seq_re, dft_seq_im, dft_hid_re, dft_hid_im):
        a = torch.einsum("bsd,ed->bse", x, dft_hid_re)
        b = torch.einsum("bsd,ed->bse", x, dft_hid_im)
        y = torch.einsum("ts,bse->bte", dft_seq_re, a) - torch.einsum("ts,bse->bte", dft_seq_im, b)
        return y

    def _B_ref(x, w_r, w_gate, w_up, w_down):
        B, S, D = x.shape
        C = 1
        r = x @ w_r
        idx = torch.argsort(-r, axis=-1)[:, :C]
        idx_e = (lambda x, n, axis: torch.repeat_interleave(x, n, dim=axis))(idx.reshape(B, C, 1), D, axis=2)
        x_sel = (lambda x, i, axis: torch.take_along_dim(x, i, dim=axis))(x, idx_e, axis=1)
        g = _silu(x_sel @ w_gate)
        u = x_sel @ w_up
        y = (g * u) @ w_down
        r_sel = _sigmoid((lambda x, i, axis: torch.take_along_dim(x, i, dim=axis))(r, idx, axis=1))
        y = y * r_sel.reshape(B, C, 1)
        b_off = (torch.arange(B) * S).reshape(B, 1)
        flat_idx = (idx + b_off).reshape(B * C)
        zero = (x * 0.0).reshape(B * S, D)
        upd = _scatter_add(zero, flat_idx, y.reshape(B * C, D), axis=0)
        return x + upd.reshape(B, S, D)

    x = A_x
    h = x + _A_ref(_layernorm(x, axis=-1), A_dft_seq_re, A_dft_seq_im, A_dft_hid_re, A_dft_hid_im)
    h2 = h + _B_ref(_layernorm(h, axis=-1), B_w_r, B_w_gate, B_w_up, B_w_down)
    return h2
```

```asm
; @launch grid=(256,1,1) block=(1024,1,1) lds=147776
.amdgcn_target "amdgcn-amd-amdhsa--gfx950"
.text
.p2align 8
.globl sequential_preLN__spectral_fnet__moe_arch_mod__prompt_kernel
.type sequential_preLN__spectral_fnet__moe_arch_mod__prompt_kernel,@function
sequential_preLN__spectral_fnet__moe_arch_mod__prompt_kernel:
    s_cmp_ge_u32 s2, 256
    s_cbranch_scc1 .Lend
    s_load_dwordx2 s[4:5], s[0:1], 0
    s_load_dwordx8 s[40:47], s[0:1], 48
    s_load_dwordx4 s[48:51], s[0:1], 80
    s_load_dwordx2 s[6:7], s[0:1], 96
    s_getpc_b64 s[30:31]
.Lpc0:
    s_add_u32 s30, s30, sequential_preLN__spectral_fnet__moe_arch_mod__prompt_kernel-.Lpc0
    s_addc_u32 s31, s31, (sequential_preLN__spectral_fnet__moe_arch_mod__prompt_kernel-.Lpc0)>>32
    v_lshlrev_b32 v4, 6, v0
    v_min_u32 v4, .Ltext_end-sequential_preLN__spectral_fnet__moe_arch_mod__prompt_kernel-4, v4
    global_load_dword v127, v4, s[30:31]
    v_lshrrev_b32 v4, 6, v0
    v_and_b32 v1, 63, v0
    v_readfirstlane_b32 s18, v4
    v_and_b32 v2, 15, v0
    v_lshrrev_b32 v3, 4, v1
    v_mov_b32 v124, 135936
    v_mov_b32 v125, 1
    v_lshl_add_u32 v4, v2, 2, v124
    v_mov_b32 v5, 0
    ds_write_b32 v4, v5
    s_and_b32 s16, s2, 7
    s_lshl_b32 s16, s16, 2
    s_lshr_b32 s19, s2, 6
    s_add_u32 s16, s16, s19
    s_bfe_u32 s17, s2, 0x30003
    s_mul_i32 s20, s17, 36
    v_lshlrev_b32 v16, 4, v1
    s_lshl_b32 s21, s2, 4
    s_add_u32 s21, s21, s18
    s_cmp_lg_u32 s21, 8
    s_cbranch_scc1 .Lf_nonon
    s_memrealtime s[22:23]
    v_mov_b32 v6, 0
    s_waitcnt lgkmcnt(0)
    s_or_b32 s22, s22, 1
    v_mov_b32 v4, s22
    v_mov_b32 v5, s23
    s_mov_b64 exec, 1
    global_store_dwordx2 v6, v[4:5], s[50:51] sc1
    s_mov_b64 exec, -1
.Lf_nonon:
    s_waitcnt lgkmcnt(0)
    s_barrier
    s_mov_b32 s8, s6
    s_mov_b32 s9, s7
    s_mov_b32 s10, 5242880
    s_mov_b32 s11, 0x00020000
    s_cmp_ge_u32 s18, 8
    s_cbranch_scc1 .Lf
    s_and_b32 s22, s18, 3
    s_lshr_b32 s23, s18, 2
    s_lshl_b32 s19, s22, 4
    s_mul_i32 s21, s22, 18432
    s_add_u32 s21, s21, 56832
    s_mul_i32 s24, s23, 9216
    s_add_u32 s24, s24, s21
    v_lshrrev_b32 v10, 3, v1
    s_lshl_b32 s25, s23, 3
    v_add_u32 v10, s25, v10
    v_lshrrev_b32 v12, 1, v10
    v_and_b32 v11, 7, v1
    v_xor_b32 v11, v11, v12
    v_add_u32 v10, s19, v10
    v_lshl_add_u32 v10, v10, 5, s16
    v_mul_u32_u24 v10, 0x480, v10
    v_lshl_add_u32 v10, v11, 4, v10
    s_mov_b32 s12, s4
    s_mov_b32 s13, s5
    s_mov_b32 s14, 2359296
    s_mov_b32 s15, 0x00020000
    s_add_u32 m0, s24, 0
    s_nop 0
    buffer_load_dwordx4 v10, s[12:15], 0 offen offset:0 lds
    s_add_u32 m0, s24, 896
    s_nop 0
    buffer_load_dwordx4 v10, s[12:15], 0 offen offset:128 lds
    s_add_u32 m0, s24, 1792
    s_nop 0
    buffer_load_dwordx4 v10, s[12:15], 0 offen offset:256 lds
    s_add_u32 m0, s24, 2688
    s_nop 0
    buffer_load_dwordx4 v10, s[12:15], 0 offen offset:384 lds
    s_add_u32 m0, s24, 3584
    s_nop 0
    buffer_load_dwordx4 v10, s[12:15], 0 offen offset:512 lds
    s_add_u32 m0, s24, 4480
    s_nop 0
    buffer_load_dwordx4 v10, s[12:15], 0 offen offset:640 lds
    s_add_u32 m0, s24, 5376
    s_nop 0
    buffer_load_dwordx4 v10, s[12:15], 0 offen offset:768 lds
    s_add_u32 m0, s24, 6272
    s_nop 0
    buffer_load_dwordx4 v10, s[12:15], 0 offen offset:896 lds
    s_add_u32 m0, s24, 7168
    s_nop 0
    buffer_load_dwordx4 v10, s[12:15], 0 offen offset:1024 lds
    s_cmp_eq_u32 s23, 0
    s_cselect_b32 s36, 6, 3
    s_cselect_b32 s37, 0, 24
    s_cselect_b32 s27, 5, 4
    s_add_u32 s37, s37, s20
    v_mul_u32_u24 v15, s36, v3
    v_add_u32 v15, s37, v15
    v_add_u32 v13, s19, v2
    v_lshl_add_u32 v8, v2, 2, v3
    v_lshlrev_b32 v8, s27, v8
    v_lshrrev_b32 v9, 3, v8
    v_and_b32 v9, 0x70, v9
    v_xor_b32 v8, v8, v9
    s_lshl_b32 s36, s18, 11
    v_add_u32 v8, s36, v8
    s_mul_i32 s26, s16, 1536
    s_mul_i32 s36, s17, 192
    s_add_u32 s26, s26, s36
    s_mul_i32 s36, s22, 786432
    s_add_u32 s26, s26, s36
    s_lshl_b32 s36, s23, 7
    s_add_u32 s26, s26, s36
    v_lshlrev_b32 v126, 4, v0
    v_mov_b32 v20, -1
    v_mov_b32 v21, -1
    v_mov_b32 v22, -1
    v_mov_b32 v23, -1
    v_mov_b32 v11, 0x7fff0000
    v_min_u32 v9, 240, v0
    v_lshlrev_b32 v9, 4, v9
    s_mul_i32 s27, s2, 3856
    s_add_u32 s27, s27, 3211264
    s_cmp_lt_u32 s18, 4
    s_cbranch_scc0 .Lc_clr2
    buffer_store_dwordx4 v[20:23], v9, s[8:11], s27 offen sc1
    s_branch .Lc_clr3
.Lc_clr2:
    v_add_u32 v9, 0xffffff00, v0
    v_lshlrev_b32 v9, 4, v9
    s_lshr_b32 s27, s2, 5
    s_mul_i32 s27, s27, 8448
    s_and_b32 s28, s2, 31
    s_mul_i32 s28, s28, 128
    s_add_u32 s27, s27, s28
    s_add_u32 s27, s27, 4325376
    v_cmp_gt_u32 vcc, 128, v9
    s_nop 1
    v_cndmask_b32 v9, v11, v9, vcc
    v_mov_b32 v24, 0
    v_mov_b32 v25, 0
    v_mov_b32 v26, 0
    v_mov_b32 v27, 0
    buffer_store_dwordx4 v[24:27], v9, s[8:11], s27 offen sc1
.Lc_clr3:
    s_mov_b64 exec, 1
    ds_add_u32 v124, v125 offset:40
    s_mov_b64 exec, -1
    v_and_b32 v21, 1, v2
    v_cvt_f32_u32 v21, v21
    v_fma_f32 v14, v21, -2.0, 1.0
    v_lshl_add_u32 v6, v3, 8, s16
    v_mul_u32_u24 v6, v6, v13
    v_cvt_f32_u32 v6, v6
    v_cvt_f32_u32 v7, v13
    v_mul_f32 v40, 0x3a000000, v6
    v_mul_f32 v7, 0x3c800000, v7
    v_add_f32 v41, v40, v7
    v_add_f32 v42, v41, v7
    v_add_f32 v43, v42, v7
    v_add_f32 v44, v43, v7
    v_add_f32 v45, v44, v7
    v_add_f32 v46, v45, v7
    v_add_f32 v47, v46, v7
    v_cos_f32 v20, v40
    v_cos_f32 v21, v41
    v_cos_f32 v22, v42
    v_cos_f32 v23, v43
    v_cos_f32 v24, v44
    v_cos_f32 v25, v45
    v_cos_f32 v26, v46
    v_cos_f32 v27, v47
    v_sin_f32_e64 v28, -v40
    v_sin_f32_e64 v29, -v41
    v_sin_f32_e64 v30, -v42
    v_sin_f32_e64 v31, -v43
    v_sin_f32_e64 v32, -v44
    v_sin_f32_e64 v33, -v45
    v_sin_f32_e64 v34, -v46
    v_sin_f32_e64 v35, -v47
    v_lshlrev_b32 v6, 31, v13
    v_lshrrev_b32 v7, 16, v6
    v_or_b32 v6, v6, v7
    v_cvt_pk_bf16_f32 v96, v20, v21
    v_cvt_pk_bf16_f32 v104, v28, v29
    v_cvt_pk_bf16_f32 v97, v22, v23
    v_cvt_pk_bf16_f32 v105, v30, v31
    v_cvt_pk_bf16_f32 v98, v24, v25
    v_cvt_pk_bf16_f32 v106, v32, v33
    v_cvt_pk_bf16_f32 v99, v26, v27
    v_cvt_pk_bf16_f32 v107, v34, v35
    v_xor_b32 v100, v6, v96
    v_xor_b32 v108, v6, v104
    v_xor_b32 v101, v6, v97
    v_xor_b32 v109, v6, v105
    v_xor_b32 v102, v6, v98
    v_xor_b32 v110, v6, v106
    v_xor_b32 v103, v6, v99
    v_xor_b32 v111, v6, v107
    v_cvt_f32_u32 v11, v15
    v_mul_f32 v20, 0x3a638e39, v11
    v_add_f32 v21, 0x3a638e39, v20
    v_add_f32 v22, 0x3a638e39, v21
    v_add_f32 v23, 0x3a638e39, v22
    v_add_f32 v24, 0x3a638e39, v23
    v_add_f32 v25, 0x3a638e39, v24
    s_add_u32 s36, s20, 36
    v_cvt_f32_u32 v11, s36
    v_mul_f32 v11, 0x3a638e39, v11
    s_cmp_eq_u32 s23, 1
    s_cselect_b64 vcc, -1, 0
    v_cndmask_b32 v23, v23, v11, vcc
    v_cos_f32 v112, v20
    v_cos_f32 v113, v21
    v_cos_f32 v114, v22
    v_cos_f32 v115, v23
    v_cos_f32 v116, v24
    v_cos_f32 v117, v25
    v_sin_f32 v118, v20
    v_sin_f32 v119, v21
    v_sin_f32 v120, v22
    v_sin_f32 v121, v23
    v_sin_f32 v122, v24
    v_sin_f32 v123, v25
    v_lshrrev_b32 v10, 3, v2
    v_mul_u32_u24 v10, 0x2400, v10
    v_and_b32 v11, 7, v2
    v_lshl_add_u32 v10, v11, 7, v10
    v_lshrrev_b32 v17, 1, v2
    v_xor_b32 v11, v17, v3
    v_lshl_add_u32 v10, v11, 4, v10
    v_add_u32 v4, s21, v10
    v_xor_b32 v5, 64, v4
    v_xor_b32 v6, 48, v4
    v_xor_b32 v7, 112, v4
    v_lshlrev_b32 v10, 4, v11
    v_lshl_add_u32 v10, v2, 7, v10
    v_xor_b32 v11, 64, v10
    v_lshrrev_b32 v9, 1, v3
    s_lshl_b32 s38, s22, 1
    v_add_u32 v9, s38, v9
    v_xor_b32 v9, v9, v17
    v_lshlrev_b32 v9, 4, v9
    v_lshl_add_u32 v9, v2, 7, v9
    v_and_b32 v17, 1, v3
    v_lshl_add_u32 v9, v17, 3, v9
    s_lshl_b32 s38, s22, 6
    v_lshl_add_u32 v12, v3, 4, s38
    v_lshlrev_b32 v13, 2, v2
    v_add_u32 v13, 147264, v13
    v_add_u32 v45, s24, v16
    v_mov_b32 v44, 0x3f803f80
    v_mov_b32 v40, 0
    v_mov_b32 v41, 0
    s_waitcnt vmcnt(9)
    ds_read_b128 v[20:23], v45
    s_waitcnt vmcnt(8)
    ds_read_b128 v[24:27], v45 offset:1024
    s_waitcnt lgkmcnt(1)
    v_dot2c_f32_bf16 v40, v20, v44
    v_dot2c_f32_bf16 v41, v20, v20
    v_dot2c_f32_bf16 v40, v21, v44
    v_dot2c_f32_bf16 v41, v21, v21
    v_dot2c_f32_bf16 v40, v22, v44
    v_dot2c_f32_bf16 v41, v22, v22
    v_dot2c_f32_bf16 v40, v23, v44
    v_dot2c_f32_bf16 v41, v23, v23
    s_waitcnt vmcnt(7)
    ds_read_b128 v[20:23], v45 offset:2048
    s_waitcnt lgkmcnt(1)
    v_dot2c_f32_bf16 v40, v24, v44
    v_dot2c_f32_bf16 v41, v24, v24
    v_dot2c_f32_bf16 v40, v25, v44
    v_dot2c_f32_bf16 v41, v25, v25
    v_dot2c_f32_bf16 v40, v26, v44
    v_dot2c_f32_bf16 v41, v26, v26
    v_dot2c_f32_bf16 v40, v27, v44
    v_dot2c_f32_bf16 v41, v27, v27
    s_waitcnt vmcnt(6)
    ds_read_b128 v[24:27], v45 offset:3072
    s_waitcnt lgkmcnt(1)
    v_dot2c_f32_bf16 v40, v20, v44
    v_dot2c_f32_bf16 v41, v20, v20
    v_dot2c_f32_bf16 v40, v21, v44
    v_dot2c_f32_bf16 v41, v21, v21
    v_dot2c_f32_bf16 v40, v22, v44
    v_dot2c_f32_bf16 v41, v22, v22
    v_dot2c_f32_bf16 v40, v23, v44
    v_dot2c_f32_bf16 v41, v23, v23
    s_waitcnt vmcnt(5)
    ds_read_b128 v[20:23], v45 offset:4096
    s_waitcnt lgkmcnt(1)
    v_dot2c_f32_bf16 v40, v24, v44
    v_dot2c_f32_bf16 v41, v24, v24
    v_dot2c_f32_bf16 v40, v25, v44
    v_dot2c_f32_bf16 v41, v25, v25
    v_dot2c_f32_bf16 v40, v26, v44
    v_dot2c_f32_bf16 v41, v26, v26
    v_dot2c_f32_bf16 v40, v27, v44
    v_dot2c_f32_bf16 v41, v27, v27
    s_waitcnt vmcnt(4)
    ds_read_b128 v[24:27], v45 offset:5120
    s_waitcnt lgkmcnt(1)
    v_dot2c_f32_bf16 v40, v20, v44
    v_dot2c_f32_bf16 v41, v20, v20
    v_dot2c_f32_bf16 v40, v21, v44
    v_dot2c_f32_bf16 v41, v21, v21
    v_dot2c_f32_bf16 v40, v22, v44
    v_dot2c_f32_bf16 v41, v22, v22
    v_dot2c_f32_bf16 v40, v23, v44
    v_dot2c_f32_bf16 v41, v23, v23
    s_waitcnt vmcnt(3)
    ds_read_b128 v[20:23], v45 offset:6144
    s_waitcnt lgkmcnt(1)
    v_dot2c_f32_bf16 v40, v24, v44
    v_dot2c_f32_bf16 v41, v24, v24
    v_dot2c_f32_bf16 v40, v25, v44
    v_dot2c_f32_bf16 v41, v25, v25
    v_dot2c_f32_bf16 v40, v26, v44
    v_dot2c_f32_bf16 v41, v26, v26
    v_dot2c_f32_bf16 v40, v27, v44
    v_dot2c_f32_bf16 v41, v27, v27
    s_waitcnt vmcnt(2)
    ds_read_b128 v[24:27], v45 offset:7168
    s_waitcnt lgkmcnt(1)
    v_dot2c_f32_bf16 v40, v20, v44
    v_dot2c_f32_bf16 v41, v20, v20
    v_dot2c_f32_bf16 v40, v21, v44
    v_dot2c_f32_bf16 v41, v21, v21
    v_dot2c_f32_bf16 v40, v22, v44
    v_dot2c_f32_bf16 v41, v22, v22
    v_dot2c_f32_bf16 v40, v23, v44
    v_dot2c_f32_bf16 v41, v23, v23
    s_waitcnt vmcnt(1)
    ds_read_b128 v[20:23], v45 offset:8192
    s_waitcnt lgkmcnt(1)
    v_dot2c_f32_bf16 v40, v24, v44
    v_dot2c_f32_bf16 v41, v24, v24
    v_dot2c_f32_bf16 v40, v25, v44
    v_dot2c_f32_bf16 v41, v25, v25
    v_dot2c_f32_bf16 v40, v26, v44
    v_dot2c_f32_bf16 v41, v26, v26
    v_dot2c_f32_bf16 v40, v27, v44
    v_dot2c_f32_bf16 v41, v27, v27
    s_waitcnt lgkmcnt(0)
    v_dot2c_f32_bf16 v40, v20, v44
    v_dot2c_f32_bf16 v41, v20, v20
    v_dot2c_f32_bf16 v40, v21, v44
    v_dot2c_f32_bf16 v41, v21, v21
    v_dot2c_f32_bf16 v40, v22, v44
    v_dot2c_f32_bf16 v41, v22, v22
    v_dot2c_f32_bf16 v40, v23, v44
    v_dot2c_f32_bf16 v41, v23, v23
    s_nop 1
    v_add_f32_dpp v40, v40, v40 quad_perm:[1,0,3,2] row_mask:0xf bank_mask:0xf
    v_add_f32_dpp v41, v41, v41 quad_perm:[1,0,3,2] row_mask:0xf bank_mask:0xf
    s_nop 0
    v_add_f32_dpp v40, v40, v40 quad_perm:[2,3,0,1] row_mask:0xf bank_mask:0xf
    v_add_f32_dpp v41, v41, v41 quad_perm:[2,3,0,1] row_mask:0xf bank_mask:0xf
    s_nop 0
    v_add_f32_dpp v40, v40, v40 row_half_mirror row_mask:0xf bank_mask:0xf
    v_add_f32_dpp v41, v41, v41 row_half_mirror row_mask:0xf bank_mask:0xf
    v_mul_f32 v40, 0x3ae38e39, v40
    v_mul_f32 v41, 0x3ae38e39, v41
    v_fma_f32 v41, -v40, v40, v41
    v_max_f32 v41, 0, v41
    v_cvt_pk_bf16_f32 v46, v40, v41
    v_lshlrev_b32 v40, 16, v46
    v_and_b32 v41, 0xffff0000, v46
    v_add_f32 v41, 0x3727c5ac, v41
    v_cvt_pk_bf16_f32 v46, v41, v41
    v_lshlrev_b32 v41, 16, v46
    v_sqrt_f32 v41, v41
    s_nop 0
    v_cvt_pk_bf16_f32 v46, v41, v41
    v_lshlrev_b32 v41, 16, v46
    v_rcp_f32 v41, v41
    v_lshrrev_b32 v17, 3, v1
    s_add_u32 s38, s19, s25
    s_lshl_b32 s38, s38, 2
    s_add_u32 s38, s38, 56320
    v_lshl_add_u32 v17, v17, 2, s38
    ds_write2_b32 v17, v41, v40 offset0:0 offset1:64
    s_mov_b64 exec, 1
    ds_add_u32 v124, v125 offset:0
    s_mov_b64 exec, -1
    s_mov_b32 s61, 0
.Lw_377:
    ds_read_b32 v126, v124 offset:0
    s_add_u32 s61, s61, 1
    s_waitcnt lgkmcnt(0)
    v_readfirstlane_b32 s60, v126
    s_cmp_ge_u32 s61, 4000000
    s_cbranch_scc1 .Lw_377_d
    s_cmp_ge_u32 s60, 16
    s_cbranch_scc0 .Lw_377
.Lw_377_d:
    s_cmp_eq_u32 s23, 1
    s_cbranch_scc1 .Lc_part1
    ds_read_b128 v[20:23], v4 offset:0
    ds_read_b128 v[24:27], v7 offset:8192
    ds_read_b128 v[40:43], v16 offset:0
    ds_read_b128 v[44:47], v16 offset:9216
    ds_read_b128 v[48:51], v16 offset:18432
    ds_read_b128 v[28:31], v5 offset:0
    ds_read_b128 v[32:35], v6 offset:8192
    ds_read_b128 v[52:55], v16 offset:1024
    ds_read_b128 v[56:59], v16 offset:10240
    ds_read_b128 v[60:63], v16 offset:19456
    s_waitcnt lgkmcnt(5)
    v_mfma_f32_16x16x32_bf16 v[72:75], v[20:23], v[40:43], 0
    v_alignbit_b32 v36, v27, v27, 16
    v_alignbit_b32 v37, v26, v26, 16
    v_mfma_f32_16x16x32_bf16 v[76:79], v[20:23], v[44:47], 0
    v_alignbit_b32 v38, v25, v25, 16
    v_alignbit_b32 v39, v24, v24, 16
    v_mfma_f32_16x16x32_bf16 v[80:83], v[20:23], v[48:51], 0
    s_nop 0
    v_mfma_f32_16x16x32_bf16 v[84:87], v[36:39], v[40:43], 0
    v_mfma_f32_16x16x32_bf16 v[88:91], v[36:39], v[44:47], 0
    v_mfma_f32_16x16x32_bf16 v[92:95], v[36:39], v[48:51], 0
    ds_read_b128 v[20:23], v4 offset:1024
    ds_read_b128 v[24:27], v7 offset:7168
    ds_read_b128 v[40:43], v16 offset:2048
    ds_read_b128 v[44:47], v16 offset:11264
    ds_read_b128 v[48:51], v16 offset:20480
    s_waitcnt lgkmcnt(5)
    v_mfma_f32_16x16x32_bf16 v[72:75], v[28:31], v[52:55], v[72:75]
    v_alignbit_b32 v36, v35, v35, 16
    v_alignbit_b32 v37, v34, v34, 16
    v_mfma_f32_16x16x32_bf16 v[76:79], v[28:31], v[56:59], v[76:79]
    v_alignbit_b32 v38, v33, v33, 16
    v_alignbit_b32 v39, v32, v32, 16
    v_mfma_f32_16x16x32_bf16 v[80:83], v[28:31], v[60:63], v[80:83]
    s_nop 0
    v_mfma_f32_16x16x32_bf16 v[84:87], v[36:39], v[52:55], v[84:87]
    v_mfma_f32_16x16x32_bf16 v[88:91], v[36:39], v[56:59], v[88:91]
    v_mfma_f32_16x16x32_bf16 v[92:95], v[36:39], v[60:63], v[92:95]
    ds_read_b128 v[28:31], v5 offset:1024
    ds_read_b128 v[32:35], v6 offset:7168
    ds_read_b128 v[52:55], v16 offset:3072
    ds_read_b128 v[56:59], v16 offset:12288
    ds_read_b128 v[60:63], v16 offset:21504
    s_waitcnt lgkmcnt(5)
    v_mfma_f32_16x16x32_bf16 v[72:75], v[20:23], v[40:43], v[72:75]
    v_alignbit_b32 v36, v27, v27, 16
    v_alignbit_b32 v37, v26, v26, 16
    v_mfma_f32_16x16x32_bf16 v[76:79], v[20:23], v[44:47], v[76:79]
    v_alignbit_b32 v38, v25, v25, 16
    v_alignbit_b32 v39, v24, v24, 16
    v_mfma_f32_16x16x32_bf16 v[80:83], v[20:23], v[48:51], v[80:83]
    s_nop 0
    v_mfma_f32_16x16x32_bf16 v[84:87], v[36:39], v[40:43], v[84:87]
    v_mfma_f32_16x16x32_bf16 v[88:91], v[36:39], v[44:47], v[88:91]
    v_mfma_f32_16x16x32_bf16 v[92:95], v[36:39], v[48:51], v[92:95]
    ds_read_b128 v[20:23], v4 offset:2048
    ds_read_b128 v[24:27], v7 offset:6144
    ds_read_b128 v[40:43], v16 offset:4096
    ds_read_b128 v[44:47], v16 offset:13312
    ds_read_b128 v[48:51], v16 offset:22528
    s_waitcnt lgkmcnt(5)
    v_mfma_f32_16x16x32_bf16 v[72:75], v[28:31], v[52:55], v[72:75]
    v_alignbit_b32 v36, v35, v35, 16
    v_alignbit_b32 v37, v34, v34, 16
    v_mfma_f32_16x16x32_bf16 v[76:79], v[28:31], v[56:59], v[76:79]
    v_alignbit_b32 v38, v33, v33, 16
    v_alignbit_b32 v39, v32, v32, 16
    v_mfma_f32_16x16x32_bf16 v[80:83], v[28:31], v[60:63], v[80:83]
    s_nop 0
    v_mfma_f32_16x16x32_bf16 v[84:87], v[36:39], v[52:55], v[84:87]
    v_mfma_f32_16x16x32_bf16 v[88:91], v[36:39], v[56:59], v[88:91]
    v_mfma_f32_16x16x32_bf16 v[92:95], v[36:39], v[60:63], v[92:95]
    ds_read_b128 v[28:31], v5 offset:2048
    ds_read_b128 v[32:35], v6 offset:6144
    ds_read_b128 v[52:55], v16 offset:5120
    ds_read_b128 v[56:59], v16 offset:14336
    ds_read_b128 v[60:63], v16 offset:23552
    s_waitcnt lgkmcnt(5)
    v_mfma_f32_16x16x32_bf16 v[72:75], v[20:23], v[40:43], v[72:75]
    v_alignbit_b32 v36, v27, v27, 16
    v_alignbit_b32 v37, v26, v26, 16
    v_mfma_f32_16x16x32_bf16 v[76:79], v[20:23], v[44:47], v[76:79]
    v_alignbit_b32 v38, v25, v25, 16
    v_alignbit_b32 v39, v24, v24, 16
    v_mfma_f32_16x16x32_bf16 v[80:83], v[20:23], v[48:51], v[80:83]
    s_nop 0
    v_mfma_f32_16x16x32_bf16 v[84:87], v[36:39], v[40:43], v[84:87]
    v_mfma_f32_16x16x32_bf16 v[88:91], v[36:39], v[44:47], v[88:91]
    v_mfma_f32_16x16x32_bf16 v[92:95], v[36:39], v[48:51], v[92:95]
    ds_read_b128 v[20:23], v4 offset:3072
    ds_read_b128 v[24:27], v7 offset:5120
    ds_read_b128 v[40:43], v16 offset:6144
    ds_read_b128 v[44:47], v16 offset:15360
    ds_read_b128 v[48:51], v16 offset:24576
    s_waitcnt lgkmcnt(5)
    v_mfma_f32_16x16x32_bf16 v[72:75], v[28:31], v[52:55], v[72:75]
    v_alignbit_b32 v36, v35, v35, 16
    v_alignbit_b32 v37, v34, v34, 16
    v_mfma_f32_16x16x32_bf16 v[76:79], v[28:31], v[56:59], v[76:79]
    v_alignbit_b32 v38, v33, v33, 16
    v_alignbit_b32 v39, v32, v32, 16
    v_mfma_f32_16x16x32_bf16 v[80:83], v[28:31], v[60:63], v[80:83]
    s_nop 0
    v_mfma_f32_16x16x32_bf16 v[84:87], v[36:39], v[52:55], v[84:87]
    v_mfma_f32_16x16x32_bf16 v[88:91], v[36:39], v[56:59], v[88:91]
    v_mfma_f32_16x16x32_bf16 v[92:95], v[36:39], v[60:63], v[92:95]
    ds_read_b128 v[28:31], v5 offset:3072
    ds_read_b128 v[32:35], v6 offset:5120
    ds_read_b128 v[52:55], v16 offset:7168
    ds_read_b128 v[56:59], v16 offset:16384
    ds_read_b128 v[60:63], v16 offset:25600
    s_waitcnt lgkmcnt(5)
    v_mfma_f32_16x16x32_bf16 v[72:75], v[20:23], v[40:43], v[72:75]
    v_alignbit_b32 v36, v27, v27, 16
    v_alignbit_b32 v37, v26, v26, 16
    v_mfma_f32_16x16x32_bf16 v[76:79], v[20:23], v[44:47], v[76:79]
    v_alignbit_b32 v38, v25, v25, 16
    v_alignbit_b32 v39, v24, v24, 16
    v_mfma_f32_16x16x32_bf16 v[80:83], v[20:23], v[48:51], v[80:83]
    s_nop 0
    v_mfma_f32_16x16x32_bf16 v[84:87], v[36:39], v[40:43], v[84:87]
    v_mfma_f32_16x16x32_bf16 v[88:91], v[36:39], v[44:47], v[88:91]
    v_mfma_f32_16x16x32_bf16 v[92:95], v[36:39], v[48:51], v[92:95]
    ds_read_b128 v[20:23], v4 offset:4096
    ds_read_b128 v[24:27], v7 offset:4096
    ds_read_b128 v[40:43], v16 offset:8192
    ds_read_b128 v[44:47], v16 offset:17408
    ds_read_b128 v[48:51], v16 offset:26624
    s_waitcnt lgkmcnt(5)
    v_mfma_f32_16x16x32_bf16 v[72:75], v[28:31], v[52:55], v[72:75]
    v_alignbit_b32 v36, v35, v35, 16
    v_alignbit_b32 v37, v34, v34, 16
    v_mfma_f32_16x16x32_bf16 v[76:79], v[28:31], v[56:59], v[76:79]
    v_alignbit_b32 v38, v33, v33, 16
    v_alignbit_b32 v39, v32, v32, 16
    v_mfma_f32_16x16x32_bf16 v[80:83], v[28:31], v[60:63], v[80:83]
    s_nop 0
    v_mfma_f32_16x16x32_bf16 v[84:87], v[36:39], v[52:55], v[84:87]
    v_mfma_f32_16x16x32_bf16 v[88:91], v[36:39], v[56:59], v[88:91]
    v_mfma_f32_16x16x32_bf16 v[92:95], v[36:39], v[60:63], v[92:95]
    ds_read_b128 v[64:67], v12 offset:56320
    ds_read_b128 v[68:71], v12 offset:56576
    ds_read_b32 v17, v13 offset:0
    ds_read_b32 v18, v13 offset:64
    ds_read_b32 v19, v13 offset:128
    s_waitcnt lgkmcnt(5)
    v_mfma_f32_16x16x32_bf16 v[72:75], v[20:23], v[40:43], v[72:75]
    v_alignbit_b32 v36, v27, v27, 16
    v_alignbit_b32 v37, v26, v26, 16
    v_mfma_f32_16x16x32_bf16 v[76:79], v[20:23], v[44:47], v[76:79]
    v_alignbit_b32 v38, v25, v25, 16
    v_alignbit_b32 v39, v24, v24, 16
    v_mfma_f32_16x16x32_bf16 v[80:83], v[20:23], v[48:51], v[80:83]
    s_nop 0
    v_mfma_f32_16x16x32_bf16 v[84:87], v[36:39], v[40:43], v[84:87]
    v_mfma_f32_16x16x32_bf16 v[88:91], v[36:39], v[44:47], v[88:91]
    v_mfma_f32_16x16x32_bf16 v[92:95], v[36:39], v[48:51], v[92:95]
    s_waitcnt lgkmcnt(0)
    s_nop 4
    v_fmac_f32 v72, v84, v14
    v_fmac_f32 v72, v68, v17
    v_mul_f32 v72, v72, v64
    v_fmac_f32 v73, v85, v14
    v_fmac_f32 v73, v69, v17
    v_mul_f32 v73, v73, v65
    v_fmac_f32 v74, v86, v14
    v_fmac_f32 v74, v70, v17
    v_mul_f32 v74, v74, v66
    v_fmac_f32 v75, v87, v14
    v_fmac_f32 v75, v71, v17
    v_mul_f32 v75, v75, v67
    v_cvt_pk_bf16_f32 v40, v72, v73
    v_cvt_pk_bf16_f32 v41, v74, v75
    ds_write_b64 v9, v[40:41] offset:46080
    v_fmac_f32 v76, v88, v14
    v_fmac_f32 v76, v68, v18
    v_mul_f32 v76, v76, v64
    v_fmac_f32 v77, v89, v14
    v_fmac_f32 v77, v69, v18
    v_mul_f32 v77, v77, v65
    v_fmac_f32 v78, v90, v14
    v_fmac_f32 v78, v70, v18
    v_mul_f32 v78, v78, v66
    v_fmac_f32 v79, v91, v14
    v_fmac_f32 v79, v71, v18
    v_mul_f32 v79, v79, v67
    v_cvt_pk_bf16_f32 v42, v76, v77
    v_cvt_pk_bf16_f32 v43, v78, v79
    ds_write_b64 v9, v[42:43] offset:48128
    v_fmac_f32 v80, v92, v14
    v_fmac_f32 v80, v68, v19
    v_mul_f32 v80, v80, v64
    v_fmac_f32 v81, v93, v14
    v_fmac_f32 v81, v69, v19
    v_mul_f32 v81, v81, v65
    v_fmac_f32 v82, v94, v14
    v_fmac_f32 v82, v70, v19
    v_mul_f32 v82, v82, v66
    v_fmac_f32 v83, v95, v14
    v_fmac_f32 v83, v71, v19
    v_mul_f32 v83, v83, v67
    v_cvt_pk_bf16_f32 v44, v80, v81
    v_cvt_pk_bf16_f32 v45, v82, v83
    ds_write_b64 v9, v[44:45] offset:50176
    s_waitcnt vmcnt(0)
    s_mov_b64 exec, 1
    ds_add_u32 v124, v125 offset:4
    s_mov_b64 exec, -1
    v_lshrrev_b32 v6, 3, v1
    v_mul_u32_u24 v6, 49152, v6
    v_and_b32 v7, 7, v1
    v_lshl_add_u32 v6, v7, 4, v6
    s_add_u32 s29, s26, 393216
    v_lshrrev_b32 v5, 3, v16
    v_and_b32 v5, 0x70, v5
    v_xor_b32 v5, v5, v16
    s_lshl_b32 s27, s18, 11
    v_add_u32 v5, s27, v5
    v_xor_b32 v4, 16, v8
    s_mov_b32 s61, 0
.Lw_598:
    ds_read_b32 v126, v124 offset:4
    s_add_u32 s61, s61, 1
    s_waitcnt lgkmcnt(0)
    v_readfirstlane_b32 s60, v126
    s_cmp_ge_u32 s61, 4000000
    s_cbranch_scc1 .Lw_598_d
    s_cmp_ge_u32 s60, 8
    s_cbranch_scc0 .Lw_598
.Lw_598_d:
    ds_read_b32 v127, v124 offset:56
    ds_read_b128 v[40:43], v10 offset:46080
    ds_read_b128 v[44:47], v11 offset:46080
    ds_read_b128 v[48:51], v10 offset:48128
    ds_read_b128 v[52:55], v11 offset:48128
    ds_read_b128 v[56:59], v10 offset:50176
    ds_read_b128 v[60:63], v11 offset:50176
    s_waitcnt lgkmcnt(4)
    v_mfma_f32_16x16x32_bf16 v[72:75], v[40:43], v[96:99], 0
    v_mfma_f32_16x16x32_bf16 v[84:87], v[40:43], v[104:107], 0
    v_mfma_f32_16x16x32_bf16 v[72:75], v[44:47], v[100:103], v[72:75]
    v_mfma_f32_16x16x32_bf16 v[84:87], v[44:47], v[108:111], v[84:87]
    s_waitcnt lgkmcnt(2)
    v_mfma_f32_16x16x32_bf16 v[76:79], v[48:51], v[96:99], 0
    v_mfma_f32_16x16x32_bf16 v[88:91], v[48:51], v[104:107], 0
    v_mfma_f32_16x16x32_bf16 v[76:79], v[52:55], v[100:103], v[76:79]
    v_mfma_f32_16x16x32_bf16 v[88:91], v[52:55], v[108:111], v[88:91]
    s_waitcnt lgkmcnt(0)
    v_mfma_f32_16x16x32_bf16 v[80:83], v[56:59], v[96:99], 0
    v_mfma_f32_16x16x32_bf16 v[92:95], v[56:59], v[104:107], 0
    v_mfma_f32_16x16x32_bf16 v[80:83], v[60:63], v[100:103], v[80:83]
    v_mfma_f32_16x16x32_bf16 v[92:95], v[60:63], v[108:111], v[92:95]
    v_readfirstlane_b32 s28, v127
    s_nop 0
    s_cmp_lg_u32 s28, 0
    s_cbranch_scc1 .Lc_tag0
    s_mov_b32 s61, 0
.Lw_632:
    ds_read_b32 v126, v124 offset:56
    s_add_u32 s61, s61, 1
    s_waitcnt lgkmcnt(0)
    v_readfirstlane_b32 s60, v126
    s_cmp_ge_u32 s61, 4000000
    s_cbranch_scc1 .Lw_632_d
    s_cmp_ge_u32 s60, 1
    s_cbranch_scc0 .Lw_632
.Lw_632_d:
    s_mov_b32 s28, s60
.Lc_tag0:
    s_nop 4
    v_sub_f32 v32, v72, v85
    v_add_f32 v33, v84, v73
    v_mul_f32 v34, v32, v112
    v_mul_f32 v35, v32, v118
    v_fma_f32 v34, -v33, v118, v34
    v_fmac_f32 v35, v33, v112
    v_cvt_pk_bf16_f32 v20, v34, v35
    v_sub_f32 v32, v74, v87
    v_add_f32 v33, v86, v75
    v_mul_f32 v34, v32, v113
    v_mul_f32 v35, v32, v119
    v_fma_f32 v34, -v33, v119, v34
    v_fmac_f32 v35, v33, v113
    v_cvt_pk_bf16_f32 v21, v34, v35
    v_sub_f32 v32, v76, v89
    v_add_f32 v33, v88, v77
    v_mul_f32 v34, v32, v114
    v_mul_f32 v35, v32, v120
    v_fma_f32 v34, -v33, v120, v34
    v_fmac_f32 v35, v33, v114
    v_cvt_pk_bf16_f32 v22, v34, v35
    v_sub_f32 v32, v78, v91
    v_add_f32 v33, v90, v79
    v_mul_f32 v34, v32, v115
    v_mul_f32 v35, v32, v121
    v_fma_f32 v34, -v33, v121, v34
    v_fmac_f32 v35, v33, v115
    v_cvt_pk_bf16_f32 v24, v34, v35
    v_sub_f32 v32, v80, v93
    v_add_f32 v33, v92, v81
    v_mul_f32 v34, v32, v116
    v_mul_f32 v35, v32, v122
    v_fma_f32 v34, -v33, v122, v34
    v_fmac_f32 v35, v33, v116
    v_cvt_pk_bf16_f32 v25, v34, v35
    v_sub_f32 v32, v82, v95
    v_add_f32 v33, v94, v83
    v_mul_f32 v34, v32, v117
    v_mul_f32 v35, v32, v123
    v_fma_f32 v34, -v33, v123, v34
    v_fmac_f32 v35, v33, v117
    v_cvt_pk_bf16_f32 v26, v34, v35
    v_mov_b32 v23, s28
    v_mov_b32 v27, s28
    ds_write_b128 v8, v[20:23] offset:0
    ds_write_b128 v4, v[24:27] offset:0
    ds_read_b128 v[28:31], v5 offset:0
    ds_read_b128 v[32:35], v5 offset:1024
    s_waitcnt lgkmcnt(1)
    buffer_store_dwordx4 v[28:31], v6, s[8:11], s26 offen sc1
    s_waitcnt lgkmcnt(0)
    buffer_store_dwordx4 v[32:35], v6, s[8:11], s29 offen sc1
    s_branch .Lc_adone
.Lc_part1:
    ds_read_b128 v[20:23], v4 offset:0
    ds_read_b128 v[24:27], v7 offset:8192
    ds_read_b128 v[40:43], v16 offset:27648
    ds_read_b128 v[44:47], v16 offset:36864
    ds_read_b128 v[28:31], v5 offset:0
    ds_read_b128 v[32:35], v6 offset:8192
    ds_read_b128 v[52:55], v16 offset:28672
    ds_read_b128 v[56:59], v16 offset:37888
    s_waitcnt lgkmcnt(4)
    v_mfma_f32_16x16x32_bf16 v[72:75], v[20:23], v[40:43], 0
    v_alignbit_b32 v36, v27, v27, 16
    v_alignbit_b32 v37, v26, v26, 16
    v_mfma_f32_16x16x32_bf16 v[76:79], v[20:23], v[44:47], 0
    v_alignbit_b32 v38, v25, v25, 16
    v_alignbit_b32 v39, v24, v24, 16
    s_nop 1
    v_mfma_f32_16x16x32_bf16 v[84:87], v[36:39], v[40:43], 0
    v_mfma_f32_16x16x32_bf16 v[88:91], v[36:39], v[44:47], 0
    ds_read_b128 v[20:23], v4 offset:1024
    ds_read_b128 v[24:27], v7 offset:7168
    ds_read_b128 v[40:43], v16 offset:29696
    ds_read_b128 v[44:47], v16 offset:38912
    s_waitcnt lgkmcnt(4)
    v_mfma_f32_16x16x32_bf16 v[72:75], v[28:31], v[52:55], v[72:75]
    v_alignbit_b32 v36, v35, v35, 16
    v_alignbit_b32 v37, v34, v34, 16
    v_mfma_f32_16x16x32_bf16 v[76:79], v[28:31], v[56:59], v[76:79]
    v_alignbit_b32 v38, v33, v33, 16
    v_alignbit_b32 v39, v32, v32, 16
    s_nop 1
    v_mfma_f32_16x16x32_bf16 v[84:87], v[36:39], v[52:55], v[84:87]
    v_mfma_f32_16x16x32_bf16 v[88:91], v[36:39], v[56:59], v[88:91]
    ds_read_b128 v[28:31], v5 offset:1024
    ds_read_b128 v[32:35], v6 offset:7168
    ds_read_b128 v[52:55], v16 offset:30720
    ds_read_b128 v[56:59], v16 offset:39936
    s_waitcnt lgkmcnt(4)
    v_mfma_f32_16x16x32_bf16 v[72:75], v[20:23], v[40:43], v[72:75]
    v_alignbit_b32 v36, v27, v27, 16
    v_alignbit_b32 v37, v26, v26, 16
    v_mfma_f32_16x16x32_bf16 v[76:79], v[20:23], v[44:47], v[76:79]
    v_alignbit_b32 v38, v25, v25, 16
    v_alignbit_b32 v39, v24, v24, 16
    s_nop 1
    v_mfma_f32_16x16x32_bf16 v[84:87], v[36:39], v[40:43], v[84:87]
    v_mfma_f32_16x16x32_bf16 v[88:91], v[36:39], v[44:47], v[88:91]
    ds_read_b128 v[20:23], v4 offset:2048
    ds_read_b128 v[24:27], v7 offset:6144
    ds_read_b128 v[40:43], v16 offset:31744
    ds_read_b128 v[44:47], v16 offset:40960
    s_waitcnt lgkmcnt(4)
    v_mfma_f32_16x16x32_bf16 v[72:75], v[28:31], v[52:55], v[72:75]
    v_alignbit_b32 v36, v35, v35, 16
    v_alignbit_b32 v37, v34, v34, 16
    v_mfma_f32_16x16x32_bf16 v[76:79], v[28:31], v[56:59], v[76:79]
    v_alignbit_b32 v38, v33, v33, 16
    v_alignbit_b32 v39, v32, v32, 16
    s_nop 1
    v_mfma_f32_16x16x32_bf16 v[84:87], v[36:39], v[52:55], v[84:87]
    v_mfma_f32_16x16x32_bf16 v[88:91], v[36:39], v[56:59], v[88:91]
    ds_read_b128 v[28:31], v5 offset:2048
    ds_read_b128 v[32:35], v6 offset:6144
    ds_read_b128 v[52:55], v16 offset:32768
    ds_read_b128 v[56:59], v16 offset:41984
    s_waitcnt lgkmcnt(4)
    v_mfma_f32_16x16x32_bf16 v[72:75], v[20:23], v[40:43], v[72:75]
    v_alignbit_b32 v36, v27, v27, 16
    v_alignbit_b32 v37, v26, v26, 16
    v_mfma_f32_16x16x32_bf16 v[76:79], v[20:23], v[44:47], v[76:79]
    v_alignbit_b32 v38, v25, v25, 16
    v_alignbit_b32 v39, v24, v24, 16
    s_nop 1
    v_mfma_f32_16x16x32_bf16 v[84:87], v[36:39], v[40:43], v[84:87]
    v_mfma_f32_16x16x32_bf16 v[88:91], v[36:39], v[44:47], v[88:91]
    ds_read_b128 v[20:23], v4 offset:3072
    ds_read_b128 v[24:27], v7 offset:5120
    ds_read_b128 v[40:43], v16 offset:33792
    ds_read_b128 v[44:47], v16 offset:43008
    s_waitcnt lgkmcnt(4)
    v_mfma_f32_16x16x32_bf16 v[72:75], v[28:31], v[52:55], v[72:75]
    v_alignbit_b32 v36, v35, v35, 16
    v_alignbit_b32 v37, v34, v34, 16
    v_mfma_f32_16x16x32_bf16 v[76:79], v[28:31], v[56:59], v[76:79]
    v_alignbit_b32 v38, v33, v33, 16
    v_alignbit_b32 v39, v32, v32, 16
    s_nop 1
    v_mfma_f32_16x16x32_bf16 v[84:87], v[36:39], v[52:55], v[84:87]
    v_mfma_f32_16x16x32_bf16 v[88:91], v[36:39], v[56:59], v[88:91]
    ds_read_b128 v[28:31], v5 offset:3072
    ds_read_b128 v[32:35], v6 offset:5120
    ds_read_b128 v[52:55], v16 offset:34816
    ds_read_b128 v[56:59], v16 offset:44032
    s_waitcnt lgkmcnt(4)
    v_mfma_f32_16x16x32_bf16 v[72:75], v[20:23], v[40:43], v[72:75]
    v_alignbit_b32 v36, v27, v27, 16
    v_alignbit_b32 v37, v26, v26, 16
    v_mfma_f32_16x16x32_bf16 v[76:79], v[20:23], v[44:47], v[76:79]
    v_alignbit_b32 v38, v25, v25, 16
    v_alignbit_b32 v39, v24, v24, 16
    s_nop 1
    v_mfma_f32_16x16x32_bf16 v[84:87], v[36:39], v[40:43], v[84:87]
    v_mfma_f32_16x16x32_bf16 v[88:91], v[36:39], v[44:47], v[88:91]
    ds_read_b128 v[20:23], v4 offset:4096
    ds_read_b128 v[24:27], v7 offset:4096
    ds_read_b128 v[40:43], v16 offset:35840
    ds_read_b128 v[44:47], v16 offset:45056
    s_waitcnt lgkmcnt(4)
    v_mfma_f32_16x16x32_bf16 v[72:75], v[28:31], v[52:55], v[72:75]
    v_alignbit_b32 v36, v35, v35, 16
    v_alignbit_b32 v37, v34, v34, 16
    v_mfma_f32_16x16x32_bf16 v[76:79], v[28:31], v[56:59], v[76:79]
    v_alignbit_b32 v38, v33, v33, 16
    v_alignbit_b32 v39, v32, v32, 16
    s_nop 1
    v_mfma_f32_16x16x32_bf16 v[84:87], v[36:39], v[52:55], v[84:87]
    v_mfma_f32_16x16x32_bf16 v[88:91], v[36:39], v[56:59], v[88:91]
    ds_read_b128 v[64:67], v12 offset:56320
    ds_read_b128 v[68:71], v12 offset:56576
    ds_read_b32 v17, v13 offset:192
    ds_read_b32 v18, v13 offset:256
    ds_read_b32 v19, v13 offset:320
    ds_read2_b32 v[80:81], v13 offset0:96 offset1:112
    s_waitcnt lgkmcnt(6)
    v_mfma_f32_16x16x32_bf16 v[72:75], v[20:23], v[40:43], v[72:75]
    v_alignbit_b32 v36, v27, v27, 16
    v_alignbit_b32 v37, v26, v26, 16
    v_mfma_f32_16x16x32_bf16 v[76:79], v[20:23], v[44:47], v[76:79]
    v_alignbit_b32 v38, v25, v25, 16
    v_alignbit_b32 v39, v24, v24, 16
    s_nop 1
    v_mfma_f32_16x16x32_bf16 v[84:87], v[36:39], v[40:43], v[84:87]
    v_mfma_f32_16x16x32_bf16 v[88:91], v[36:39], v[44:47], v[88:91]
    s_waitcnt lgkmcnt(0)
    v_add_f32 v18, v18, v19
    v_add_f32 v80, v80, v81
    v_add_f32 v18, v18, v80
    s_nop 2
    v_fmac_f32 v72, v84, v14
    v_fmac_f32 v72, v68, v17
    v_mul_f32 v72, v72, v64
    v_fmac_f32 v73, v85, v14
    v_fmac_f32 v73, v69, v17
    v_mul_f32 v73, v73, v65
    v_fmac_f32 v74, v86, v14
    v_fmac_f32 v74, v70, v17
    v_mul_f32 v74, v74, v66
    v_fmac_f32 v75, v87, v14
    v_fmac_f32 v75, v71, v17
    v_mul_f32 v75, v75, v67
    v_cvt_pk_bf16_f32 v40, v72, v73
    v_cvt_pk_bf16_f32 v41, v74, v75
    ds_write_b64 v9, v[40:41] offset:52224
    v_fmac_f32 v76, v88, v14
    v_fmac_f32 v76, v68, v18
    v_mul_f32 v76, v76, v64
    v_fmac_f32 v77, v89, v14
    v_fmac_f32 v77, v69, v18
    v_mul_f32 v77, v77, v65
    v_fmac_f32 v78, v90, v14
    v_fmac_f32 v78, v70, v18
    v_mul_f32 v78, v78, v66
    v_fmac_f32 v79, v91, v14
    v_fmac_f32 v79, v71, v18
    v_mul_f32 v79, v79, v67
    v_cvt_pk_bf16_f32 v42, v76, v77
    v_cvt_pk_bf16_f32 v43, v78, v79
    ds_write_b64 v9, v[42:43] offset:54272
    s_waitcnt vmcnt(0)
    s_mov_b64 exec, 1
    ds_add_u32 v124, v125 offset:4
    s_mov_b64 exec, -1
    v_lshrrev_b32 v6, 2, v1
    v_mul_u32_u24 v6, 49152, v6
    v_and_b32 v7, 3, v1
    v_lshl_add_u32 v6, v7, 4, v6
    s_add_u32 s29, s26, 393216
    v_lshrrev_b32 v5, 3, v16
    v_and_b32 v5, 0x70, v5
    v_xor_b32 v5, v5, v16
    s_lshl_b32 s27, s18, 11
    v_add_u32 v5, s27, v5
    v_xor_b32 v4, 16, v8
    s_mov_b32 s61, 0
.Lw_868:
    ds_read_b32 v126, v124 offset:4
    s_add_u32 s61, s61, 1
    s_waitcnt lgkmcnt(0)
    v_readfirstlane_b32 s60, v126
    s_cmp_ge_u32 s61, 4000000
    s_cbranch_scc1 .Lw_868_d
    s_cmp_ge_u32 s60, 8
    s_cbranch_scc0 .Lw_868
.Lw_868_d:
    ds_read_b32 v127, v124 offset:56
    ds_read_b128 v[40:43], v10 offset:52224
    ds_read_b128 v[44:47], v11 offset:52224
    ds_read_b128 v[48:51], v10 offset:54272
    ds_read_b128 v[52:55], v11 offset:54272
    s_waitcnt lgkmcnt(2)
    v_mfma_f32_16x16x32_bf16 v[72:75], v[40:43], v[96:99], 0
    v_mfma_f32_16x16x32_bf16 v[84:87], v[40:43], v[104:107], 0
    v_mfma_f32_16x16x32_bf16 v[72:75], v[44:47], v[100:103], v[72:75]
    v_mfma_f32_16x16x32_bf16 v[84:87], v[44:47], v[108:111], v[84:87]
    s_waitcnt lgkmcnt(0)
    v_mfma_f32_16x16x32_bf16 v[76:79], v[48:51], v[96:99], 0
    v_mfma_f32_16x16x32_bf16 v[88:91], v[48:51], v[104:107], 0
    v_mfma_f32_16x16x32_bf16 v[76:79], v[52:55], v[100:103], v[76:79]
    v_mfma_f32_16x16x32_bf16 v[88:91], v[52:55], v[108:111], v[88:91]
    v_readfirstlane_b32 s28, v127
    s_nop 0
    s_cmp_lg_u32 s28, 0
    s_cbranch_scc1 .Lc_tag1
    s_mov_b32 s61, 0
.Lw_895:
    ds_read_b32 v126, v124 offset:56
    s_add_u32 s61, s61, 1
    s_waitcnt lgkmcnt(0)
    v_readfirstlane_b32 s60, v126
    s_cmp_ge_u32 s61, 4000000
    s_cbranch_scc1 .Lw_895_d
    s_cmp_ge_u32 s60, 1
    s_cbranch_scc0 .Lw_895
.Lw_895_d:
    s_mov_b32 s28, s60
.Lc_tag1:
    s_nop 4
    v_sub_f32 v32, v72, v85
    v_add_f32 v33, v84, v73
    v_mul_f32 v34, v32, v112
    v_mul_f32 v35, v32, v118
    v_fma_f32 v34, -v33, v118, v34
    v_fmac_f32 v35, v33, v112
    v_cvt_pk_bf16_f32 v20, v34, v35
    v_sub_f32 v32, v74, v87
    v_add_f32 v33, v86, v75
    v_mul_f32 v34, v32, v113
    v_mul_f32 v35, v32, v119
    v_fma_f32 v34, -v33, v119, v34
    v_fmac_f32 v35, v33, v113
    v_cvt_pk_bf16_f32 v21, v34, v35
    v_sub_f32 v32, v76, v89
    v_add_f32 v33, v88, v77
    v_mul_f32 v34, v32, v114
    v_mul_f32 v35, v32, v120
    v_fma_f32 v34, -v33, v120, v34
    v_fmac_f32 v35, v33, v114
    v_cvt_pk_bf16_f32 v22, v34, v35
    v_sub_f32 v32, v78, v91
    v_add_f32 v33, v90, v79
    v_mul_f32 v34, v32, v115
    v_mul_f32 v35, v32, v121
    v_fma_f32 v34, -v33, v121, v34
    v_fmac_f32 v35, v33, v115
    v_cvt_pk_bf16_f32 v24, v34, v35
    v_mov_b32 v23, s28
    v_mov_b32 v27, s28
    ds_write_b128 v8, v[20:23] offset:0
    ds_read_b128 v[28:31], v5 offset:0
    s_waitcnt lgkmcnt(0)
    buffer_store_dwordx4 v[28:31], v6, s[8:11], s26 offen sc1
    s_cmp_lg_u32 s17, 7
    s_cbranch_scc1 .Lc_adone
    s_lshl_b32 s27, s16, 6
    s_add_u32 s27, s27, s19
    s_lshl_b32 s27, s27, 4
    s_add_u32 s27, s27, 4259840
    s_mov_b64 exec, 0xffff
    buffer_store_dwordx4 v[24:27], v16, s[8:11], s27 offen sc1
    s_mov_b64 exec, -1
.Lc_adone:
    s_mov_b64 exec, 1
    ds_add_u32 v124, v125 offset:8
    s_mov_b64 exec, -1
    v_mul_u32_u24 v4, 8448, v2
    s_bfe_u32 s17, s2, 0x20003
    s_sub_u32 s19, 64, s16
    s_cmp_eq_u32 s16, 0
    s_cselect_b32 s19, 32, s19
    s_bitcmp1_b32 s2, 5
    s_cselect_b32 s16, s19, s16
    s_sub_u32 s19, 64, s16
    s_and_b32 s19, s19, 63
    s_mul_i32 s38, s18, 192
    s_lshl_b32 s39, s17, 3
    v_bfe_u32 v9, v0, 5, 3
    v_add_u32 v10, s39, v9
    v_lshl_add_u32 v10, v10, 6, s16
    v_and_b32 v11, 31, v0
    v_mul_u32_u24 v7, 0x480, v10
    v_lshl_add_u32 v8, v11, 2, v7
    v_lshl_add_u32 v7, v11, 4, v7
    v_lshlrev_b32 v12, 4, v11
    v_lshlrev_b32 v13, 2, v11
    v_mul_u32_u24 v9, 2320, v9
    v_add_u32 v9, 56832, v9
    v_lshl_add_u32 v29, v11, 5, v9
    v_lshl_add_u32 v39, v11, 3, v9
    s_cmp_lt_u32 s18, 4
    s_cbranch_scc1 .Lb_nox
    s_mov_b32 s12, s48
    s_mov_b32 s13, s49
    s_mov_b32 s14, 2359296
    s_mov_b32 s15, 0x00020000
    s_mov_b32 s52, 0x00003f80
    s_mov_b32 s53, 0x3f800000
    s_lshl_b32 s55, s16, 2
    s_add_u32 s55, s55, s17
    s_mul_i32 s54, s55, 2560
    s_add_u32 s54, s54, 3211264
    s_mul_i32 s55, s55, 16
    s_add_u32 s55, s55, 4325376
    s_mov_b32 s61, 0
.Lw_990:
    ds_read_b32 v126, v124 offset:52
    s_add_u32 s61, s61, 1
    s_waitcnt lgkmcnt(0)
    v_readfirstlane_b32 s60, v126
    s_cmp_ge_u32 s61, 4000000
    s_cbranch_scc1 .Lw_990_d
    s_cmp_ge_u32 s60, 5
    s_cbranch_scc0 .Lw_990
.Lw_990_d:
    v_bfe_u32 v40, v0, 5, 3
    v_mul_u32_u24 v40, 0x480, v40
    v_add_u32 v40, 136000, v40
    v_add_u32 v41, v40, v12
    v_add_u32 v40, v40, v13
    v_add_u32 v42, 145216, v12
    v_add_u32 v43, 145216, v13
    ds_read_b128 v[20:23], v41
    ds_read_b128 v[24:27], v41 offset:512
    ds_read_b32 v28, v40 offset:1024
    ds_read_b128 v[30:33], v42
    ds_read_b128 v[34:37], v42 offset:512
    ds_read_b32 v38, v43 offset:1024
    s_cmp_eq_u32 s18, 7
    s_cbranch_scc1 .Lb_epi7
.Lb_nox:
    v_mul_u32_u24 v19, 6144, v3
    v_lshl_add_u32 v19, v2, 4, v19
    s_lshl_b32 s37, s18, 8
    s_mul_i32 s32, s16, 49152
    s_add_u32 s32, s32, s37
    v_add_u32 v6, s32, v19
    s_mul_i32 s32, s19, 49152
    s_add_u32 s32, s32, s37
    v_add_u32 v5, s32, v19
    s_movk_i32 s35, 1536
    s_mov_b32 s34, 15
    s_cmp_lg_u32 s18, 6
    s_cbranch_scc1 .Lb_n6
    s_lshl_b32 s32, s16, 4
    s_add_u32 s32, s32, 4259840
    v_lshl_add_u32 v6, v3, 12, s32
    s_movk_i32 s35, 1024
    s_mov_b32 s34, 3
.Lb_n6:
    s_mov_b32 s29, s28
    s_sleep 38
    buffer_load_dwordx4 v[40:43], v6, s[8:11], 0 offen
    s_mul_i32 s36, s35, 1
    buffer_load_dwordx4 v[44:47], v6, s[8:11], s36 offen
    s_mul_i32 s36, s35, 2
    buffer_load_dwordx4 v[48:51], v6, s[8:11], s36 offen
    s_mul_i32 s36, s35, 3
    buffer_load_dwordx4 v[52:55], v6, s[8:11], s36 offen
    s_mul_i32 s36, s35, 16
    buffer_load_dwordx4 v[56:59], v6, s[8:11], s36 offen
    s_mul_i32 s36, s35, 17
    buffer_load_dwordx4 v[60:63], v6, s[8:11], s36 offen
    s_mul_i32 s36, s35, 18
    buffer_load_dwordx4 v[64:67], v6, s[8:11], s36 offen
    s_mul_i32 s36, s35, 19
    buffer_load_dwordx4 v[68:71], v6, s[8:11], s36 offen
    s_cmp_eq_u32 s18, 6
    s_cbranch_scc1 .Lb_l6
    buffer_load_dwordx4 v[72:75], v5, s[8:11], 0 offen
    s_mul_i32 s36, s35, 1
    buffer_load_dwordx4 v[76:79], v5, s[8:11], s36 offen
    s_mul_i32 s36, s35, 2
    buffer_load_dwordx4 v[80:83], v5, s[8:11], s36 offen
    s_mul_i32 s36, s35, 3
    buffer_load_dwordx4 v[84:87], v5, s[8:11], s36 offen
    s_mul_i32 s36, s35, 16
    buffer_load_dwordx4 v[88:91], v5, s[8:11], s36 offen
    s_mul_i32 s36, s35, 17
    buffer_load_dwordx4 v[92:95], v5, s[8:11], s36 offen
    s_mul_i32 s36, s35, 18
    buffer_load_dwordx4 v[96:99], v5, s[8:11], s36 offen
    s_mul_i32 s36, s35, 19
    buffer_load_dwordx4 v[100:103], v5, s[8:11], s36 offen
.Lb_l6:
    s_mov_b64 exec, 1
    ds_add_u32 v124, v125 offset:48
    s_mov_b64 exec, -1
    v_and_b32 v16, 7, v2
    v_add_u32 v16, s39, v16
    v_lshl_add_u32 v17, v16, 6, s16
    v_sub_u32 v17, 0x800, v17
    v_bfe_u32 v17, v17, 6, 5
    v_lshlrev_b32 v18, 2, v3
    v_cvt_f32_u32 v18, v18
    v_cvt_f32_u32 v19, v16
    v_mul_f32 v19, 0x3d000000, v19
    v_mul_f32 v112, v18, v19
    v_add_f32 v113, v112, v19
    v_add_f32 v114, v113, v19
    v_add_f32 v115, v114, v19
    v_cos_f32 v116, v112
    v_cos_f32 v117, v113
    v_cos_f32 v118, v114
    v_cos_f32 v119, v115
    v_sin_f32 v120, v112
    v_sin_f32 v121, v113
    v_sin_f32 v122, v114
    v_sin_f32 v123, v115
    v_lshlrev_b32 v14, 31, v16
    v_lshrrev_b32 v19, 16, v14
    v_or_b32 v14, v14, v19
    v_cvt_pk_bf16_f32 v104, v116, v120
    v_cvt_pk_bf16_f32 v105, v117, v121
    v_cvt_pk_bf16_f32 v106, v118, v122
    v_cvt_pk_bf16_f32 v107, v119, v123
    v_cvt_f32_u32 v19, v17
    v_mul_f32 v19, 0x3d000000, v19
    v_mul_f32 v112, v18, v19
    v_add_f32 v113, v112, v19
    v_add_f32 v114, v113, v19
    v_add_f32 v115, v114, v19
    v_cos_f32 v116, v112
    v_cos_f32 v117, v113
    v_cos_f32 v118, v114
    v_cos_f32 v119, v115
    v_sin_f32 v120, v112
    v_sin_f32 v121, v113
    v_sin_f32 v122, v114
    v_sin_f32 v123, v115
    v_lshlrev_b32 v15, 31, v17
    v_lshrrev_b32 v19, 16, v15
    v_or_b32 v15, v15, v19
    v_cvt_pk_bf16_f32 v108, v116, v120
    v_cvt_pk_bf16_f32 v109, v117, v121
    v_cvt_pk_bf16_f32 v110, v118, v122
    v_cvt_pk_bf16_f32 v111, v119, v123
    v_mul_u32_u24 v16, 2320, v2
    v_mul_u32_u24 v18, 48, v3
    s_sub_u32 s37, 59092, s38
    v_sub_u32 v17, v16, v18
    v_add_u32 v17, s37, v17
    s_add_u32 s37, s38, 56832
    v_add3_u32 v16, v16, v18, s37
    s_mov_b32 s37, 0
    s_cmp_eq_u32 s18, 6
    s_cbranch_scc0 .Lb_z
    s_waitcnt vmcnt(0)
.Lb_z:
.Lb_zt0:
    s_waitcnt vmcnt(12)
    s_bitcmp1_b32 s34, 0
    s_cbranch_scc0 .Lb_zs0
    v_swap_b32 v41, v44
    v_swap_b32 v42, v48
    v_swap_b32 v43, v52
    v_swap_b32 v46, v49
    v_swap_b32 v47, v53
    v_swap_b32 v51, v54
    v_cmp_ne_u64 vcc, s[28:29], v[52:53]
    v_cmp_ne_u64 s[32:33], s[28:29], v[54:55]
    s_nop 0
    s_or_b64 vcc, vcc, s[32:33]
    s_cbranch_scc1 .Lb_zr0
    s_bitset0_b32 s34, 0
.Lb_zs0:
    s_waitcnt vmcnt(8)
    s_bitcmp1_b32 s34, 1
    s_cbranch_scc0 .Lb_zs1
    v_swap_b32 v57, v60
    v_swap_b32 v58, v64
    v_swap_b32 v59, v68
    v_swap_b32 v62, v65
    v_swap_b32 v63, v69
    v_swap_b32 v67, v70
    v_cmp_ne_u64 vcc, s[28:29], v[68:69]
    v_cmp_ne_u64 s[32:33], s[28:29], v[70:71]
    s_nop 0
    s_or_b64 vcc, vcc, s[32:33]
    s_cbranch_scc1 .Lb_zr1
    s_bitset0_b32 s34, 1
.Lb_zs1:
    s_and_b32 s36, s34, 3
    s_cbranch_scc1 .Lb_zw0
.Lb_zd0:
    s_nop 0
    v_mfma_f32_16x16x32_bf16 v[112:115], v[40:43], v[104:107], 0
    v_mfma_f32_16x16x32_bf16 v[116:119], v[44:47], v[104:107], 0
    v_mfma_f32_16x16x32_bf16 v[120:123], v[48:51], v[104:107], 0
    v_xor_b32 v104, v14, v104
    v_xor_b32 v105, v14, v105
    v_xor_b32 v106, v14, v106
    v_xor_b32 v107, v14, v107
    s_nop 1
    v_mfma_f32_16x16x32_bf16 v[112:115], v[56:59], v[104:107], v[112:115]
    v_mfma_f32_16x16x32_bf16 v[116:119], v[60:63], v[104:107], v[116:119]
    v_mfma_f32_16x16x32_bf16 v[120:123], v[64:67], v[104:107], v[120:123]
    s_cmp_lg_u32 s18, 6
    s_cbranch_scc1 .Lb_w6
    s_mov_b64 exec, 0xff
    s_nop 7
    ds_write_b32 v16, v112
    s_branch .Lb_yd
.Lb_w6:
    s_nop 5
    s_mov_b32 exec_lo, 0x00ff00ff
    s_mov_b32 exec_hi, 0x00ff00ff
    ds_write2_b32 v16, v112, v113 offset0:0 offset1:3
    ds_write2_b32 v16, v114, v115 offset0:6 offset1:9
    ds_write2_b32 v16, v116, v117 offset0:1 offset1:4
    ds_write2_b32 v16, v118, v119 offset0:7 offset1:10
    ds_write2_b32 v16, v120, v121 offset0:2 offset1:5
    ds_write2_b32 v16, v122, v123 offset0:8 offset1:11
    s_mov_b64 exec, -1
.Lb_zt1:
    s_waitcnt vmcnt(4)
    s_bitcmp1_b32 s34, 2
    s_cbranch_scc0 .Lb_zs2
    v_swap_b32 v73, v76
    v_swap_b32 v74, v80
    v_swap_b32 v75, v84
    v_swap_b32 v78, v81
    v_swap_b32 v79, v85
    v_swap_b32 v83, v86
    v_cmp_ne_u64 vcc, s[28:29], v[84:85]
    v_cmp_ne_u64 s[32:33], s[28:29], v[86:87]
    s_nop 0
    s_or_b64 vcc, vcc, s[32:33]
    s_cbranch_scc1 .Lb_zr2
    s_bitset0_b32 s34, 2
.Lb_zs2:
    s_waitcnt vmcnt(0)
    s_bitcmp1_b32 s34, 3
    s_cbranch_scc0 .Lb_zs3
    v_swap_b32 v89, v92
    v_swap_b32 v90, v96
    v_swap_b32 v91, v100
    v_swap_b32 v94, v97
    v_swap_b32 v95, v101
    v_swap_b32 v99, v102
    v_cmp_ne_u64 vcc, s[28:29], v[100:101]
    v_cmp_ne_u64 s[32:33], s[28:29], v[102:103]
    s_nop 0
    s_or_b64 vcc, vcc, s[32:33]
    s_cbranch_scc1 .Lb_zr3
    s_bitset0_b32 s34, 3
.Lb_zs3:
    s_and_b32 s36, s34, 12
    s_cbranch_scc1 .Lb_zw1
.Lb_zd1:
    s_nop 0
    v_mfma_f32_16x16x32_bf16 v[112:115], v[72:75], v[108:111], 0
    v_mfma_f32_16x16x32_bf16 v[116:119], v[76:79], v[108:111], 0
    v_mfma_f32_16x16x32_bf16 v[120:123], v[80:83], v[108:111], 0
    v_xor_b32 v108, v15, v108
    v_xor_b32 v109, v15, v109
    v_xor_b32 v110, v15, v110
    v_xor_b32 v111, v15, v111
    s_nop 1
    v_mfma_f32_16x16x32_bf16 v[112:115], v[88:91], v[108:111], v[112:115]
    v_mfma_f32_16x16x32_bf16 v[116:119], v[92:95], v[108:111], v[116:119]
    v_mfma_f32_16x16x32_bf16 v[120:123], v[96:99], v[108:111], v[120:123]
    s_mov_b32 exec_lo, 0x00ff00ff
    s_mov_b32 exec_hi, 0x00ff00ff
    s_nop 3
    ds_write2_b32 v17, v112, v113 offset0:11 offset1:8
    ds_write2_b32 v17, v114, v115 offset0:5 offset1:2
    ds_write2_b32 v17, v116, v117 offset0:10 offset1:7
    ds_write2_b32 v17, v118, v119 offset0:4 offset1:1
    ds_write2_b32 v17, v120, v121 offset0:9 offset1:6
    ds_write2_b32 v17, v122, v123 offset0:3 offset1:0
    s_mov_b64 exec, -1
.Lb_yd:
    s_mov_b64 exec, 1
    ds_add_u32 v124, v125 offset:16
    s_mov_b64 exec, -1
    s_cmp_lt_u32 s18, 4
    s_cbranch_scc1 .Lend
.Lb_epi:
    v_mov_b32 v70, 0
    s_mov_b32 s61, 0
.Lw_1246:
    ds_read_b32 v126, v124 offset:16
    s_add_u32 s61, s61, 1
    s_waitcnt lgkmcnt(0)
    v_readfirstlane_b32 s60, v126
    s_cmp_ge_u32 s61, 4000000
    s_cbranch_scc1 .Lw_1246_d
    s_cmp_ge_u32 s60, 7
    s_cbranch_scc0 .Lw_1246
.Lw_1246_d:
    ds_read_b128 v[40:43], v29
    ds_read_b128 v[44:47], v29 offset:16
    ds_read_b128 v[48:51], v29 offset:1024
    ds_read_b128 v[52:55], v29 offset:1040
    ds_read_b64 v[56:57], v39 offset:2048
    s_waitcnt lgkmcnt(4)
    v_dot2_f32_bf16 v40, v20, s52, v40
    v_dot2_f32_bf16 v41, v20, s53, v41
    v_dot2_f32_bf16 v42, v21, s52, v42
    v_dot2_f32_bf16 v43, v21, s53, v43
    s_waitcnt lgkmcnt(3)
    v_dot2_f32_bf16 v44, v22, s52, v44
    v_dot2_f32_bf16 v45, v22, s53, v45
    v_dot2_f32_bf16 v46, v23, s52, v46
    v_dot2_f32_bf16 v47, v23, s53, v47
    s_waitcnt lgkmcnt(2)
    v_dot2_f32_bf16 v48, v24, s52, v48
    v_dot2_f32_bf16 v49, v24, s53, v49
    v_dot2_f32_bf16 v50, v25, s52, v50
    v_dot2_f32_bf16 v51, v25, s53, v51
    s_waitcnt lgkmcnt(1)
    v_dot2_f32_bf16 v52, v26, s52, v52
    v_dot2_f32_bf16 v53, v26, s53, v53
    v_dot2_f32_bf16 v54, v27, s52, v54
    v_dot2_f32_bf16 v55, v27, s53, v55
    s_waitcnt lgkmcnt(0)
    v_dot2_f32_bf16 v56, v28, s52, v56
    v_dot2_f32_bf16 v57, v28, s53, v57
    v_pk_add_f32 v[60:61], v[40:41], v[42:43]
    v_pk_mul_f32 v[62:63], v[40:41], v[40:41]
    v_pk_fma_f32 v[62:63], v[42:43], v[42:43], v[62:63]
    v_pk_add_f32 v[60:61], v[60:61], v[44:45]
    v_pk_fma_f32 v[62:63], v[44:45], v[44:45], v[62:63]
    v_pk_add_f32 v[60:61], v[60:61], v[46:47]
    v_pk_fma_f32 v[62:63], v[46:47], v[46:47], v[62:63]
    v_pk_add_f32 v[60:61], v[60:61], v[48:49]
    v_pk_fma_f32 v[62:63], v[48:49], v[48:49], v[62:63]
    v_pk_add_f32 v[60:61], v[60:61], v[50:51]
    v_pk_fma_f32 v[62:63], v[50:51], v[50:51], v[62:63]
    v_pk_add_f32 v[60:61], v[60:61], v[52:53]
    v_pk_fma_f32 v[62:63], v[52:53], v[52:53], v[62:63]
    v_pk_add_f32 v[60:61], v[60:61], v[54:55]
    v_pk_fma_f32 v[62:63], v[54:55], v[54:55], v[62:63]
    v_pk_add_f32 v[60:61], v[60:61], v[56:57]
    v_pk_fma_f32 v[62:63], v[56:57], v[56:57], v[62:63]
    v_add_f32 v60, v60, v61
    v_add_f32 v62, v62, v63
    s_nop 0
    v_add_f32_dpp v60, v60, v60 quad_perm:[1,0,3,2] row_mask:0xf bank_mask:0xf
    v_add_f32_dpp v62, v62, v62 quad_perm:[1,0,3,2] row_mask:0xf bank_mask:0xf
    s_nop 0
    v_add_f32_dpp v60, v60, v60 quad_perm:[2,3,0,1] row_mask:0xf bank_mask:0xf
    v_add_f32_dpp v62, v62, v62 quad_perm:[2,3,0,1] row_mask:0xf bank_mask:0xf
    s_nop 0
    v_add_f32_dpp v60, v60, v60 row_half_mirror row_mask:0xf bank_mask:0xf
    v_add_f32_dpp v62, v62, v62 row_half_mirror row_mask:0xf bank_mask:0xf
    s_nop 0
    v_add_f32_dpp v60, v60, v60 row_mirror row_mask:0xf bank_mask:0xf
    v_add_f32_dpp v62, v62, v62 row_mirror row_mask:0xf bank_mask:0xf
    v_mov_b32 v61, v60
    v_mov_b32 v63, v62
    s_nop 0
    v_permlane16_swap_b32 v60, v61
    v_permlane16_swap_b32 v62, v63
    v_add_f32 v60, v60, v61
    v_add_f32 v62, v62, v63
    v_mul_f32 v60, 0x3ae38e39, v60
    v_mul_f32 v62, 0x3ae38e39, v62
    v_fma_f32 v62, -v60, v60, v62
    v_max_f32 v62, 0, v62
    v_cvt_pk_bf16_f32 v64, v60, v62
    v_lshlrev_b32 v60, 16, v64
    v_and_b32 v62, 0xffff0000, v64
    v_add_f32 v62, 0x3727c5ac, v62
    v_cvt_pk_bf16_f32 v64, v62, v62
    v_lshlrev_b32 v62, 16, v64
    v_sqrt_f32 v62, v62
    s_nop 0
    v_cvt_pk_bf16_f32 v64, v62, v62
    v_lshlrev_b32 v62, 16, v64
    v_rcp_f32 v62, v62
    s_nop 0
    v_mul_f32 v60, v60, v62
    v_add_f32 v64, 1.0, v62
    v_mov_b32 v66, 0
    v_pk_fma_f32 v[68:69], v[40:41], v[62:63], v[60:61] op_sel_hi:[1,0,0] neg_lo:[0,0,1] neg_hi:[0,0,1]
    v_cvt_pk_bf16_f32 v72, v68, v69
    v_dot2c_f32_bf16 v66, v72, v30
    v_pk_fma_f32 v[68:69], v[42:43], v[62:63], v[60:61] op_sel_hi:[1,0,0] neg_lo:[0,0,1] neg_hi:[0,0,1]
    v_cvt_pk_bf16_f32 v73, v68, v69
    v_dot2c_f32_bf16 v66, v73, v31
    v_pk_fma_f32 v[68:69], v[44:45], v[62:63], v[60:61] op_sel_hi:[1,0,0] neg_lo:[0,0,1] neg_hi:[0,0,1]
    v_cvt_pk_bf16_f32 v74, v68, v69
    v_dot2c_f32_bf16 v66, v74, v32
    v_pk_fma_f32 v[68:69], v[46:47], v[62:63], v[60:61] op_sel_hi:[1,0,0] neg_lo:[0,0,1] neg_hi:[0,0,1]
    v_cvt_pk_bf16_f32 v75, v68, v69
    v_dot2c_f32_bf16 v66, v75, v33
    v_pk_fma_f32 v[68:69], v[48:49], v[62:63], v[60:61] op_sel_hi:[1,0,0] neg_lo:[0,0,1] neg_hi:[0,0,1]
    v_cvt_pk_bf16_f32 v76, v68, v69
    v_dot2c_f32_bf16 v66, v76, v34
    v_pk_fma_f32 v[68:69], v[50:51], v[62:63], v[60:61] op_sel_hi:[1,0,0] neg_lo:[0,0,1] neg_hi:[0,0,1]
    v_cvt_pk_bf16_f32 v77, v68, v69
    v_dot2c_f32_bf16 v66, v77, v35
    v_pk_fma_f32 v[68:69], v[52:53], v[62:63], v[60:61] op_sel_hi:[1,0,0] neg_lo:[0,0,1] neg_hi:[0,0,1]
    v_cvt_pk_bf16_f32 v78, v68, v69
    v_dot2c_f32_bf16 v66, v78, v36
    v_pk_fma_f32 v[68:69], v[54:55], v[62:63], v[60:61] op_sel_hi:[1,0,0] neg_lo:[0,0,1] neg_hi:[0,0,1]
    v_cvt_pk_bf16_f32 v79, v68, v69
    v_dot2c_f32_bf16 v66, v79, v37
    v_pk_fma_f32 v[68:69], v[56:57], v[62:63], v[60:61] op_sel_hi:[1,0,0] neg_lo:[0,0,1] neg_hi:[0,0,1]
    v_cvt_pk_bf16_f32 v80, v68, v69
    v_dot2c_f32_bf16 v66, v80, v38
    s_nop 2
    v_add_f32_dpp v66, v66, v66 quad_perm:[1,0,3,2] row_mask:0xf bank_mask:0xf
    s_nop 1
    v_add_f32_dpp v66, v66, v66 quad_perm:[2,3,0,1] row_mask:0xf bank_mask:0xf
    s_nop 1
    v_add_f32_dpp v66, v66, v66 row_half_mirror row_mask:0xf bank_mask:0xf
    s_nop 1
    v_add_f32_dpp v66, v66, v66 row_mirror row_mask:0xf bank_mask:0xf
    v_mov_b32 v67, v66
    s_nop 1
    v_permlane16_swap_b32 v66, v67
    v_add_f32 v66, v66, v67
    v_ashrrev_i32 v67, 31, v66
    v_or_b32 v67, 0x80000000, v67
    v_xor_b32 v67, v67, v66
    v_and_b32 v67, 0xfffff000, v67
    v_or_b32 v67, v67, v10
    v_or_b32 v67, 0x800, v67
    s_mov_b32 exec_lo, 1
    s_mov_b32 exec_hi, 1
    ds_max_u32 v124, v67 offset:36
    s_mov_b64 exec, 1
    ds_add_u32 v124, v125 offset:20
    s_mov_b64 exec, -1
    v_min_u32 v72, -2, v72
    v_min_u32 v73, -2, v73
    v_min_u32 v74, -2, v74
    v_min_u32 v75, -2, v75
    v_min_u32 v76, -2, v76
    v_min_u32 v77, -2, v77
    v_min_u32 v78, -2, v78
    v_min_u32 v79, -2, v79
    v_min_u32 v80, -2, v80
    s_mov_b32 s61, 0
.Lw_1388:
    ds_read_b32 v126, v124 offset:20
    s_add_u32 s61, s61, 1
    s_waitcnt lgkmcnt(0)
    v_readfirstlane_b32 s60, v126
    s_cmp_ge_u32 s61, 4000000
    s_cbranch_scc1 .Lw_1388_d
    s_cmp_ge_u32 s60, 4
    s_cbranch_scc0 .Lw_1388
.Lw_1388_d:
    ds_read_b32 v71, v124 offset:36
    s_waitcnt lgkmcnt(0)
    v_cmp_eq_u32 vcc, v71, v67
    s_nop 0
    s_and_saveexec_b64 s[30:31], vcc
    s_cbranch_execz .Lb_nw
    buffer_store_dwordx4 v[72:75], v12, s[8:11], s54 offen sc1
    buffer_store_dwordx4 v[76:79], v12, s[8:11], s54 offen offset:512 sc1
    buffer_store_dword v80, v13, s[8:11], s54 offen offset:1024 sc1
    s_and_b32 exec_lo, exec_lo, 255
    s_and_b32 exec_hi, exec_hi, 255
    buffer_store_dword v67, v4, s[8:11], s55 offen sc1
.Lb_nw:
    s_mov_b64 exec, -1
    v_pk_fma_f32 v[68:69], v[40:41], v[64:65], v[60:61] op_sel_hi:[1,0,0] neg_lo:[0,0,1] neg_hi:[0,0,1]
    v_cvt_pk_bf16_f32 v84, v68, v69
    v_pk_fma_f32 v[68:69], v[42:43], v[64:65], v[60:61] op_sel_hi:[1,0,0] neg_lo:[0,0,1] neg_hi:[0,0,1]
    v_cvt_pk_bf16_f32 v85, v68, v69
    v_pk_fma_f32 v[68:69], v[44:45], v[64:65], v[60:61] op_sel_hi:[1,0,0] neg_lo:[0,0,1] neg_hi:[0,0,1]
    v_cvt_pk_bf16_f32 v86, v68, v69
    v_pk_fma_f32 v[68:69], v[46:47], v[64:65], v[60:61] op_sel_hi:[1,0,0] neg_lo:[0,0,1] neg_hi:[0,0,1]
    v_cvt_pk_bf16_f32 v87, v68, v69
    v_pk_fma_f32 v[68:69], v[48:49], v[64:65], v[60:61] op_sel_hi:[1,0,0] neg_lo:[0,0,1] neg_hi:[0,0,1]
    v_cvt_pk_bf16_f32 v88, v68, v69
    v_pk_fma_f32 v[68:69], v[50:51], v[64:65], v[60:61] op_sel_hi:[1,0,0] neg_lo:[0,0,1] neg_hi:[0,0,1]
    v_cvt_pk_bf16_f32 v89, v68, v69
    v_pk_fma_f32 v[68:69], v[52:53], v[64:65], v[60:61] op_sel_hi:[1,0,0] neg_lo:[0,0,1] neg_hi:[0,0,1]
    v_cvt_pk_bf16_f32 v90, v68, v69
    v_pk_fma_f32 v[68:69], v[54:55], v[64:65], v[60:61] op_sel_hi:[1,0,0] neg_lo:[0,0,1] neg_hi:[0,0,1]
    v_cvt_pk_bf16_f32 v91, v68, v69
    v_pk_fma_f32 v[68:69], v[56:57], v[64:65], v[60:61] op_sel_hi:[1,0,0] neg_lo:[0,0,1] neg_hi:[0,0,1]
    v_cvt_pk_bf16_f32 v92, v68, v69
    buffer_store_dwordx4 v[84:87], v7, s[12:15], 0 offen sc1
    buffer_store_dwordx4 v[88:91], v7, s[12:15], 0 offen offset:512 sc1
    buffer_store_dword v92, v8, s[12:15], 0 offen offset:1024 sc1
    s_mov_b64 exec, vcc
    s_cbranch_execz .Lb_done
    v_cvt_pk_bf16_f32 v20, v40, v41
    v_cvt_pk_bf16_f32 v21, v42, v43
    v_cvt_pk_bf16_f32 v22, v44, v45
    v_cvt_pk_bf16_f32 v23, v46, v47
    v_cvt_pk_bf16_f32 v24, v48, v49
    v_cvt_pk_bf16_f32 v25, v50, v51
    v_cvt_pk_bf16_f32 v26, v52, v53
    v_cvt_pk_bf16_f32 v27, v54, v55
    v_cvt_pk_bf16_f32 v28, v56, v57
    v_min_u32 v20, -2, v20
    v_min_u32 v21, -2, v21
    v_min_u32 v22, -2, v22
    v_min_u32 v23, -2, v23
    v_min_u32 v24, -2, v24
    v_min_u32 v25, -2, v25
    v_min_u32 v26, -2, v26
    v_min_u32 v27, -2, v27
    v_min_u32 v28, -2, v28
    v_min_u32 v66, -2, v66
    buffer_store_dwordx4 v[20:23], v12, s[8:11], s54 offen offset:1152 sc1
    buffer_store_dwordx4 v[24:27], v12, s[8:11], s54 offen offset:1664 sc1
    buffer_store_dword v28, v13, s[8:11], s54 offen offset:2176 sc1
    s_waitcnt vmcnt(0)
    buffer_store_dword v66, v70, s[8:11], s54 offen offset:2304 sc1
.Lb_done:
    s_endpgm
.Lb_zr0:
    buffer_load_dwordx4 v[40:43], v6, s[8:11], 0 offen sc1
    s_mul_i32 s36, s35, 1
    buffer_load_dwordx4 v[44:47], v6, s[8:11], s36 offen sc1
    s_mul_i32 s36, s35, 2
    buffer_load_dwordx4 v[48:51], v6, s[8:11], s36 offen sc1
    s_mul_i32 s36, s35, 3
    buffer_load_dwordx4 v[52:55], v6, s[8:11], s36 offen sc1
    s_branch .Lb_zs0
.Lb_zr1:
    s_mul_i32 s36, s35, 16
    buffer_load_dwordx4 v[56:59], v6, s[8:11], s36 offen sc1
    s_mul_i32 s36, s35, 17
    buffer_load_dwordx4 v[60:63], v6, s[8:11], s36 offen sc1
    s_mul_i32 s36, s35, 18
    buffer_load_dwordx4 v[64:67], v6, s[8:11], s36 offen sc1
    s_mul_i32 s36, s35, 19
    buffer_load_dwordx4 v[68:71], v6, s[8:11], s36 offen sc1
    s_branch .Lb_zs1
.Lb_zr2:
    buffer_load_dwordx4 v[72:75], v5, s[8:11], 0 offen sc1
    s_mul_i32 s36, s35, 1
    buffer_load_dwordx4 v[76:79], v5, s[8:11], s36 offen sc1
    s_mul_i32 s36, s35, 2
    buffer_load_dwordx4 v[80:83], v5, s[8:11], s36 offen sc1
    s_mul_i32 s36, s35, 3
    buffer_load_dwordx4 v[84:87], v5, s[8:11], s36 offen sc1
    s_branch .Lb_zs2
.Lb_zr3:
    s_mul_i32 s36, s35, 16
    buffer_load_dwordx4 v[88:91], v5, s[8:11], s36 offen sc1
    s_mul_i32 s36, s35, 17
    buffer_load_dwordx4 v[92:95], v5, s[8:11], s36 offen sc1
    s_mul_i32 s36, s35, 18
    buffer_load_dwordx4 v[96:99], v5, s[8:11], s36 offen sc1
    s_mul_i32 s36, s35, 19
    buffer_load_dwordx4 v[100:103], v5, s[8:11], s36 offen sc1
    s_branch .Lb_zs3
.Lb_zw0:
    s_add_u32 s37, s37, 1
    s_waitcnt vmcnt(0)
    s_cmp_lt_u32 s37, 100000
    s_cbranch_scc1 .Lb_zt0
    s_branch .Lb_zd0
.Lb_zw1:
    s_add_u32 s37, s37, 1
    s_waitcnt vmcnt(0)
    s_cmp_lt_u32 s37, 100000
    s_cbranch_scc1 .Lb_zt1
    s_branch .Lb_zd1
.Lb_epi7:
    s_mov_b32 s61, 0
.Lw_1501:
    ds_read_b32 v126, v124 offset:48
    s_add_u32 s61, s61, 1
    s_waitcnt lgkmcnt(0)
    v_readfirstlane_b32 s60, v126
    s_cmp_ge_u32 s61, 4000000
    s_cbranch_scc1 .Lw_1501_d
    s_cmp_ge_u32 s60, 7
    s_cbranch_scc1 .Lw_1501_d
    s_sleep 4
    s_branch .Lw_1501
.Lw_1501_d:
    s_mov_b32 s61, 0
.Lw_1512:
    ds_read_b32 v126, v124 offset:16
    s_add_u32 s61, s61, 1
    s_waitcnt lgkmcnt(0)
    v_readfirstlane_b32 s60, v126
    s_cmp_ge_u32 s61, 4000000
    s_cbranch_scc1 .Lw_1512_d
    s_cmp_ge_u32 s60, 5
    s_cbranch_scc1 .Lw_1512_d
    s_sleep 1
    s_branch .Lw_1512
.Lw_1512_d:
    s_branch .Lb_epi
.Lf:
    v_mov_b32 v121, 0
    s_sub_u32 s30, s18, 8
    s_min_u32 s32, s30, 4
    s_sub_u32 s31, s30, s32
    s_lshl_b32 s31, s31, 6
    s_cmp_ge_u32 s32, 3
    s_cselect_b32 s33, 3, 6
    s_cselect_b32 s34, 18, 0
    s_lshl_b32 s35, s32, 1
    s_add_u32 s34, s34, s35
    s_add_u32 s34, s34, s20
    v_lshrrev_b32 v20, 2, v2
    v_mul_u32_u24 v20, s33, v20
    v_bfe_u32 v21, v2, 1, 1
    v_add3_u32 v20, v20, v21, s34
    s_cmp_eq_u32 s32, 4
    s_cselect_b32 s33, 1, 2
    v_cmp_eq_u32 vcc, s33, v21
    s_add_u32 s33, s20, 36
    v_mov_b32 v21, s33
    v_cndmask_b32 v20, v20, v21, vcc
    v_cvt_f32_u32 v20, v20
    v_mul_f32 v30, 0x3ae38e39, v20
    v_and_b32 v21, 1, v2
    v_cvt_f32_u32 v21, v21
    v_mul_f32 v32, 0x3e800000, v21
    v_mul_f32 v28, 0x42000000, v30
    v_add_f32 v34, v28, v32
    v_cos_f32 v28, v28
    v_lshl_add_u32 v22, v3, 3, s31
    v_cvt_f32_u32 v22, v22
    v_add_f32 v20, 0.5, v22
    v_add_f32 v21, 1.0, v20
    v_add_f32 v22, 1.0, v21
    v_add_f32 v23, 1.0, v22
    v_add_f32 v24, 1.0, v23
    v_add_f32 v25, 1.0, v24
    v_add_f32 v26, 1.0, v25
    v_add_f32 v27, 1.0, v26
    v_add_f32 v28, v28, v28
    s_mul_i32 s33, s32, 9216
    s_lshl_b32 s31, s31, 5
    s_add_u32 s33, s33, s31
    v_add_u32 v19, s33, v16
    s_cmp_lt_u32 s30, 4
    s_cselect_b32 s31, 9, 2
    s_cmp_eq_u32 s30, 7
    s_cselect_b32 s31, 3, s31
    v_mov_b32 v36, 0
    v_mov_b32 v37, 0x3f803f80
    v_pk_fma_f32 v[40:41], v[20:21], v[30:31], v[32:33] op_sel_hi:[1,0,0]
    v_pk_fma_f32 v[42:43], v[22:23], v[30:31], v[32:33] op_sel_hi:[1,0,0]
    v_pk_fma_f32 v[44:45], v[24:25], v[30:31], v[32:33] op_sel_hi:[1,0,0]
    v_pk_fma_f32 v[46:47], v[26:27], v[30:31], v[32:33] op_sel_hi:[1,0,0]
    v_cos_f32 v40, v40
    v_cos_f32 v41, v41
    v_cos_f32 v42, v42
    v_cos_f32 v43, v43
    v_cos_f32 v44, v44
    v_cos_f32 v45, v45
    v_cos_f32 v46, v46
    v_cos_f32 v47, v47
    v_pk_fma_f32 v[48:49], v[20:21], v[30:31], v[34:35] op_sel_hi:[1,0,0]
    v_pk_fma_f32 v[50:51], v[22:23], v[30:31], v[34:35] op_sel_hi:[1,0,0]
    v_pk_fma_f32 v[52:53], v[24:25], v[30:31], v[34:35] op_sel_hi:[1,0,0]
    v_pk_fma_f32 v[54:55], v[26:27], v[30:31], v[34:35] op_sel_hi:[1,0,0]
    v_cos_f32 v48, v48
    v_cos_f32 v49, v49
    v_cos_f32 v50, v50
    v_cos_f32 v51, v51
    v_cos_f32 v52, v52
    v_cos_f32 v53, v53
    v_cos_f32 v54, v54
    v_cos_f32 v55, v55
    v_cvt_pk_bf16_f32 v64, v40, v41
    v_cvt_pk_bf16_f32 v65, v42, v43
    v_cvt_pk_bf16_f32 v66, v44, v45
    v_cvt_pk_bf16_f32 v67, v46, v47
    ds_write_b128 v19, v[64:67] offset:0
    v_dot2c_f32_bf16 v36, v64, v37
    v_dot2c_f32_bf16 v36, v65, v37
    v_dot2c_f32_bf16 v36, v66, v37
    v_dot2c_f32_bf16 v36, v67, v37
    v_cvt_pk_bf16_f32 v68, v48, v49
    v_cvt_pk_bf16_f32 v69, v50, v51
    v_cvt_pk_bf16_f32 v70, v52, v53
    v_cvt_pk_bf16_f32 v71, v54, v55
    ds_write_b128 v19, v[68:71] offset:1024
    v_dot2c_f32_bf16 v36, v68, v37
    v_dot2c_f32_bf16 v36, v69, v37
    v_dot2c_f32_bf16 v36, v70, v37
    v_dot2c_f32_bf16 v36, v71, v37
    s_cmp_eq_u32 s31, 2
    s_cbranch_scc1 .Lw_sum
    v_pk_fma_f32 v[56:57], v[48:49], v[28:29], v[40:41] op_sel_hi:[1,0,1] neg_lo:[0,0,1] neg_hi:[0,0,1]
    v_pk_fma_f32 v[58:59], v[50:51], v[28:29], v[42:43] op_sel_hi:[1,0,1] neg_lo:[0,0,1] neg_hi:[0,0,1]
    v_pk_fma_f32 v[60:61], v[52:53], v[28:29], v[44:45] op_sel_hi:[1,0,1] neg_lo:[0,0,1] neg_hi:[0,0,1]
    v_pk_fma_f32 v[62:63], v[54:55], v[28:29], v[46:47] op_sel_hi:[1,0,1] neg_lo:[0,0,1] neg_hi:[0,0,1]
    v_cvt_pk_bf16_f32 v64, v56, v57
    v_cvt_pk_bf16_f32 v65, v58, v59
    v_cvt_pk_bf16_f32 v66, v60, v61
    v_cvt_pk_bf16_f32 v67, v62, v63
    ds_write_b128 v19, v[64:67] offset:2048
    v_dot2c_f32_bf16 v36, v64, v37
    v_dot2c_f32_bf16 v36, v65, v37
    v_dot2c_f32_bf16 v36, v66, v37
    v_dot2c_f32_bf16 v36, v67, v37
    s_cmp_eq_u32 s31, 3
    s_cbranch_scc1 .Lw_sum
    v_pk_fma_f32 v[40:41], v[56:57], v[28:29], v[48:49] op_sel_hi:[1,0,1] neg_lo:[0,0,1] neg_hi:[0,0,1]
    v_pk_fma_f32 v[42:43], v[58:59], v[28:29], v[50:51] op_sel_hi:[1,0,1] neg_lo:[0,0,1] neg_hi:[0,0,1]
    v_pk_fma_f32 v[44:45], v[60:61], v[28:29], v[52:53] op_sel_hi:[1,0,1] neg_lo:[0,0,1] neg_hi:[0,0,1]
    v_pk_fma_f32 v[46:47], v[62:63], v[28:29], v[54:55] op_sel_hi:[1,0,1] neg_lo:[0,0,1] neg_hi:[0,0,1]
    v_cvt_pk_bf16_f32 v68, v40, v41
    v_cvt_pk_bf16_f32 v69, v42, v43
    v_cvt_pk_bf16_f32 v70, v44, v45
    v_cvt_pk_bf16_f32 v71, v46, v47
    ds_write_b128 v19, v[68:71] offset:3072
    v_dot2c_f32_bf16 v36, v68, v37
    v_dot2c_f32_bf16 v36, v69, v37
    v_dot2c_f32_bf16 v36, v70, v37
    v_dot2c_f32_bf16 v36, v71, v37
    v_pk_fma_f32 v[48:49], v[40:41], v[28:29], v[56:57] op_sel_hi:[1,0,1] neg_lo:[0,0,1] neg_hi:[0,0,1]
    v_pk_fma_f32 v[50:51], v[42:43], v[28:29], v[58:59] op_sel_hi:[1,0,1] neg_lo:[0,0,1] neg_hi:[0,0,1]
    v_pk_fma_f32 v[52:53], v[44:45], v[28:29], v[60:61] op_sel_hi:[1,0,1] neg_lo:[0,0,1] neg_hi:[0,0,1]
    v_pk_fma_f32 v[54:55], v[46:47], v[28:29], v[62:63] op_sel_hi:[1,0,1] neg_lo:[0,0,1] neg_hi:[0,0,1]
    v_cvt_pk_bf16_f32 v64, v48, v49
    v_cvt_pk_bf16_f32 v65, v50, v51
    v_cvt_pk_bf16_f32 v66, v52, v53
    v_cvt_pk_bf16_f32 v67, v54, v55
    ds_write_b128 v19, v[64:67] offset:4096
    v_dot2c_f32_bf16 v36, v64, v37
    v_dot2c_f32_bf16 v36, v65, v37
    v_dot2c_f32_bf16 v36, v66, v37
    v_dot2c_f32_bf16 v36, v67, v37
    v_pk_fma_f32 v[56:57], v[48:49], v[28:29], v[40:41] op_sel_hi:[1,0,1] neg_lo:[0,0,1] neg_hi:[0,0,1]
    v_pk_fma_f32 v[58:59], v[50:51], v[28:29], v[42:43] op_sel_hi:[1,0,1] neg_lo:[0,0,1] neg_hi:[0,0,1]
    v_pk_fma_f32 v[60:61], v[52:53], v[28:29], v[44:45] op_sel_hi:[1,0,1] neg_lo:[0,0,1] neg_hi:[0,0,1]
    v_pk_fma_f32 v[62:63], v[54:55], v[28:29], v[46:47] op_sel_hi:[1,0,1] neg_lo:[0,0,1] neg_hi:[0,0,1]
    v_cvt_pk_bf16_f32 v68, v56, v57
    v_cvt_pk_bf16_f32 v69, v58, v59
    v_cvt_pk_bf16_f32 v70, v60, v61
    v_cvt_pk_bf16_f32 v71, v62, v63
    ds_write_b128 v19, v[68:71] offset:5120
    v_dot2c_f32_bf16 v36, v68, v37
    v_dot2c_f32_bf16 v36, v69, v37
    v_dot2c_f32_bf16 v36, v70, v37
    v_dot2c_f32_bf16 v36, v71, v37
    v_pk_fma_f32 v[40:41], v[56:57], v[28:29], v[48:49] op_sel_hi:[1,0,1] neg_lo:[0,0,1] neg_hi:[0,0,1]
    v_pk_fma_f32 v[42:43], v[58:59], v[28:29], v[50:51] op_sel_hi:[1,0,1] neg_lo:[0,0,1] neg_hi:[0,0,1]
    v_pk_fma_f32 v[44:45], v[60:61], v[28:29], v[52:53] op_sel_hi:[1,0,1] neg_lo:[0,0,1] neg_hi:[0,0,1]
    v_pk_fma_f32 v[46:47], v[62:63], v[28:29], v[54:55] op_sel_hi:[1,0,1] neg_lo:[0,0,1] neg_hi:[0,0,1]
    v_cvt_pk_bf16_f32 v64, v40, v41
    v_cvt_pk_bf16_f32 v65, v42, v43
    v_cvt_pk_bf16_f32 v66, v44, v45
    v_cvt_pk_bf16_f32 v67, v46, v47
    ds_write_b128 v19, v[64:67] offset:6144
    v_dot2c_f32_bf16 v36, v64, v37
    v_dot2c_f32_bf16 v36, v65, v37
    v_dot2c_f32_bf16 v36, v66, v37
    v_dot2c_f32_bf16 v36, v67, v37
    v_pk_fma_f32 v[48:49], v[40:41], v[28:29], v[56:57] op_sel_hi:[1,0,1] neg_lo:[0,0,1] neg_hi:[0,0,1]
    v_pk_fma_f32 v[50:51], v[42:43], v[28:29], v[58:59] op_sel_hi:[1,0,1] neg_lo:[0,0,1] neg_hi:[0,0,1]
    v_pk_fma_f32 v[52:53], v[44:45], v[28:29], v[60:61] op_sel_hi:[1,0,1] neg_lo:[0,0,1] neg_hi:[0,0,1]
    v_pk_fma_f32 v[54:55], v[46:47], v[28:29], v[62:63] op_sel_hi:[1,0,1] neg_lo:[0,0,1] neg_hi:[0,0,1]
    v_cvt_pk_bf16_f32 v68, v48, v49
    v_cvt_pk_bf16_f32 v69, v50, v51
    v_cvt_pk_bf16_f32 v70, v52, v53
    v_cvt_pk_bf16_f32 v71, v54, v55
    ds_write_b128 v19, v[68:71] offset:7168
    v_dot2c_f32_bf16 v36, v68, v37
    v_dot2c_f32_bf16 v36, v69, v37
    v_dot2c_f32_bf16 v36, v70, v37
    v_dot2c_f32_bf16 v36, v71, v37
    v_pk_fma_f32 v[56:57], v[48:49], v[28:29], v[40:41] op_sel_hi:[1,0,1] neg_lo:[0,0,1] neg_hi:[0,0,1]
    v_pk_fma_f32 v[58:59], v[50:51], v[28:29], v[42:43] op_sel_hi:[1,0,1] neg_lo:[0,0,1] neg_hi:[0,0,1]
    v_pk_fma_f32 v[60:61], v[52:53], v[28:29], v[44:45] op_sel_hi:[1,0,1] neg_lo:[0,0,1] neg_hi:[0,0,1]
    v_pk_fma_f32 v[62:63], v[54:55], v[28:29], v[46:47] op_sel_hi:[1,0,1] neg_lo:[0,0,1] neg_hi:[0,0,1]
    v_cvt_pk_bf16_f32 v64, v56, v57
    v_cvt_pk_bf16_f32 v65, v58, v59
    v_cvt_pk_bf16_f32 v66, v60, v61
    v_cvt_pk_bf16_f32 v67, v62, v63
    ds_write_b128 v19, v[64:67] offset:8192
    v_dot2c_f32_bf16 v36, v64, v37
    v_dot2c_f32_bf16 v36, v65, v37
    v_dot2c_f32_bf16 v36, v66, v37
    v_dot2c_f32_bf16 v36, v67, v37
.Lw_sum:
    s_nop 2
    v_mov_b32 v37, v36
    s_nop 1
    v_permlane16_swap_b32 v36, v37
    v_add_f32 v36, v36, v37
    v_mov_b32 v37, v36
    s_nop 1
    v_permlane32_swap_b32 v36, v37
    v_add_f32 v36, v36, v37
    v_fma_f32 v37, v32, 4.0, -1.0
    v_mul_f32 v36, v36, v37
    v_add_f32 v36, v36, v36
    s_lshl_b32 s33, s30, 6
    s_add_u32 s33, s33, 147264
    v_lshl_add_u32 v37, v2, 2, s33
    ds_write_b32 v37, v36
    s_mov_b64 exec, 1
    ds_add_u32 v124, v125 offset:0
    s_mov_b64 exec, -1
    s_cmp_ge_u32 s18, 13
    s_cbranch_scc1 .Lf_pf
    s_bfe_u32 s21, s2, 0x20003
    s_sub_u32 s22, 64, s16
    s_cmp_eq_u32 s16, 0
    s_cselect_b32 s22, 32, s22
    s_bitcmp1_b32 s2, 5
    s_cselect_b32 s22, s22, s16
    s_lshl_b32 s21, s21, 9
    s_add_u32 s22, s22, s21
    s_mul_i32 s22, s22, 1152
    s_mov_b32 s12, s4
    s_mov_b32 s13, s5
    s_mov_b32 s14, 2359296
    s_mov_b32 s15, 0x00020000
    s_lshl_b32 s21, s32, 7
    s_add_u32 s23, s21, 0
    v_add_u32 v4, s23, v1
    v_mul_u32_u24 v5, 0x38f, v4
    v_lshrrev_b32 v5, 16, v5
    v_mul_u32_u24 v5, 72576, v5
    v_lshl_add_u32 v4, v4, 4, v5
    s_lshl_b32 s23, s23, 4
    s_add_u32 m0, s23, 136000
    s_nop 0
    buffer_load_dwordx4 v4, s[12:15], s22 offen lds
    s_add_u32 s23, s21, 64
    v_add_u32 v4, s23, v1
    v_mul_u32_u24 v5, 0x38f, v4
    v_lshrrev_b32 v5, 16, v5
    v_mul_u32_u24 v5, 72576, v5
    v_lshl_add_u32 v4, v4, 4, v5
    s_lshl_b32 s23, s23, 4
    s_add_u32 m0, s23, 136000
    s_cmp_eq_u32 s32, 4
    s_cbranch_scc1 .Lf_wr
    buffer_load_dwordx4 v4, s[12:15], s22 offen lds
    s_branch .Lf_xd
.Lf_wr:
    s_mov_b32 s12, s40
    s_mov_b32 s13, s41
    s_mov_b32 s14, 1152
    s_mov_b32 s15, 0x00020000
    buffer_load_dwordx4 v16, s[12:15], 0 offen lds
    buffer_load_dwordx4 v16, s[12:15], 0 offen offset:1024 lds
.Lf_xd:
    s_cmp_lg_u32 s18, 9
    s_cbranch_scc1 .Lf_yd
    s_mov_b32 s61, 0
.Lw_1773:
    ds_read_b32 v126, v124 offset:40
    s_add_u32 s61, s61, 1
    s_waitcnt lgkmcnt(0)
    v_readfirstlane_b32 s60, v126
    s_cmp_ge_u32 s61, 4000000
    s_cbranch_scc1 .Lw_1773_d
    s_cmp_ge_u32 s60, 8
    s_cbranch_scc0 .Lw_1773
.Lw_1773_d:
    global_load_dwordx2 v[122:123], v121, s[50:51] sc1
    s_mov_b64 exec, 1
    ds_add_u32 v124, v125 offset:40
    s_mov_b64 exec, -1
    s_branch .Lf_yd
.Lf_yd:
    s_waitcnt vmcnt(0)
    s_mov_b64 exec, 1
    ds_add_u32 v124, v125 offset:52
    s_mov_b64 exec, -1
    s_branch .Lf_pfd
.Lf_pf:
    s_lshr_b32 s21, s2, 3
    s_and_b32 s22, s2, 7
    s_mul_i32 s23, s21, 165888
    s_mul_i32 s24, s22, 1152
    s_add_u32 s23, s23, s24
    s_mul_i32 s24, s22, 663552
    s_mul_i32 s25, s21, 20736
    s_add_u32 s24, s24, s25
    s_cmp_eq_u32 s18, 14
    s_cselect_b32 s52, s44, s42
    s_cselect_b32 s53, s45, s43
    s_cmp_eq_u32 s18, 15
    s_cselect_b32 s52, s46, s52
    s_cselect_b32 s53, s47, s53
    s_cselect_b32 s23, s24, s23
    s_cselect_b32 s25, 0, 8064
    s_add_u32 s52, s52, s23
    s_addc_u32 s53, s53, 0
    v_add_u32 v4, 0, v1
    v_min_u32 v4, 161, v4
    v_mul_u32_u24 v6, 0x1c72, v4
    v_lshrrev_b32 v6, 16, v6
    v_mul_u32_u24 v6, s25, v6
    v_lshl_add_u32 v8, v4, 7, v6
    v_add_u32 v4, 64, v1
    v_min_u32 v4, 161, v4
    v_mul_u32_u24 v6, 0x1c72, v4
    v_lshrrev_b32 v6, 16, v6
    v_mul_u32_u24 v6, s25, v6
    v_lshl_add_u32 v9, v4, 7, v6
    v_add_u32 v4, 128, v1
    v_min_u32 v4, 161, v4
    v_mul_u32_u24 v6, 0x1c72, v4
    v_lshrrev_b32 v6, 16, v6
    v_mul_u32_u24 v6, s25, v6
    v_lshl_add_u32 v10, v4, 7, v6
    s_cmp_lg_u32 s18, 15
    s_cbranch_scc1 .Lf_pfe
    s_mov_b32 s61, 0
.Lw_1830:
    ds_read_b32 v126, v124 offset:48
    s_add_u32 s61, s61, 1
    s_waitcnt lgkmcnt(0)
    v_readfirstlane_b32 s60, v126
    s_cmp_ge_u32 s61, 4000000
    s_cbranch_scc1 .Lw_1830_d
    s_cmp_ge_u32 s60, 7
    s_cbranch_scc1 .Lw_1830_d
    s_sleep 4
    s_branch .Lw_1830
.Lw_1830_d:
.Lf_pfe:
    s_mov_b32 s61, 0
.Lw_1841:
    ds_read_b32 v126, v124 offset:40
    s_add_u32 s61, s61, 1
    s_waitcnt lgkmcnt(0)
    v_readfirstlane_b32 s60, v126
    s_cmp_ge_u32 s61, 4000000
    s_cbranch_scc1 .Lw_1841_d
    s_cmp_ge_u32 s60, 9
    s_cbranch_scc1 .Lw_1841_d
    s_sleep 1
    s_branch .Lw_1841
.Lw_1841_d:
.Lf_pfgo:
    global_load_dword v40, v8, s[52:53]
    global_load_dword v41, v9, s[52:53]
    global_load_dword v42, v10, s[52:53]
.Lf_pfd:
    s_cmp_lg_u32 s18, 9
    s_cbranch_scc1 .Lf_nocp
    s_mov_b32 s27, 0
    s_waitcnt vmcnt(0)
.Lf_non:
    v_readfirstlane_b32 s28, v122
    s_add_u32 s27, s27, 1
    s_cmp_lg_u32 s28, 0
    s_cbranch_scc1 .Lf_non_done
    global_load_dwordx2 v[122:123], v121, s[50:51] sc1
    s_waitcnt vmcnt(0)
    s_cmp_lt_u32 s27, 100000
    s_cbranch_scc1 .Lf_non
.Lf_non_done:
    ds_write_b64 v124, v[122:123] offset:56
.Lf_nocp:
    s_sub_u32 s18, s18, 8
    v_mul_u32_u24 v12, 16, v1
    s_and_b32 s34, s2, 7
    s_mul_i32 s34, s34, 8448
    s_add_u32 s39, s34, 4325376
    s_add_u32 s34, s34, 4325376
    s_bfe_u32 s15, s2, 0x40003
    s_cmp_lt_u32 s15, 9
    s_cbranch_scc0 .Lend
    s_lshr_b32 s17, s2, 7
    s_mul_i32 s17, s17, 9
    s_add_u32 s17, s17, s15
    s_and_b32 s16, s2, 7
    s_mul_i32 s16, s16, 18
    s_add_u32 s16, s16, s17
    v_lshrrev_b32 v4, 3, v2
    v_lshl_add_u32 v5, v4, 2, v3
    s_mul_i32 s19, s18, 72
    v_lshl_add_u32 v13, v5, 1, s19
    v_mul_u32_u24 v6, 0x2400, v13
    v_and_b32 v7, 3, v2
    v_lshl_add_u32 v6, v7, 4, v6
    s_lshl_b32 s21, s16, 6
    v_add_u32 v6, s21, v6
    v_mov_b32 v7, 0
    v_sub_u32 v30, 15, v5
    v_mul_u32_u24 v30, 0x2400, v30
    v_mov_b32 v31, 0
    v_lshlrev_b32 v13, 1, v13
    v_add_u32 v28, 134656, v13
    v_and_b32 v29, 6, v5
    v_add_u32 v29, s19, v29
    v_lshlrev_b32 v29, 1, v29
    v_add_u32 v29, 134784, v29
    s_lshl_b32 s21, s16, 5
    v_add_u32 v8, s21, v5
    v_mul_u32_u24 v8, 0x480, v8
    v_and_b32 v9, 7, v2
    v_lshl_add_u32 v8, v9, 4, v8
    s_lshl_b32 s21, s18, 7
    v_add_u32 v8, s21, v8
    v_and_b32 v10, 4, v2
    v_cmp_ne_u32 vcc, 0, v10
    s_movk_i32 s30, 9216
    s_mov_b32 s31, 0
    s_mov_b32 s32, 138240
    s_mov_b32 s33, 0
    s_movk_i32 s35, 18432
    s_movk_i32 s36, 27648
    v_mov_b32 v10, s42
    v_mov_b32 v11, s44
    v_cndmask_b32 v10, v10, v11, vcc
    v_mov_b32 v11, s43
    v_mov_b32 v14, s45
    v_cndmask_b32 v11, v11, v14, vcc
    v_lshl_add_u64 v[6:7], v[6:7], 0, v[10:11]
    s_mov_b32 s61, 0
.Lw_1924:
    ds_read_b32 v126, v124 offset:8
    s_add_u32 s61, s61, 1
    s_waitcnt lgkmcnt(0)
    v_readfirstlane_b32 s60, v126
    s_cmp_ge_u32 s61, 4000000
    s_cbranch_scc1 .Lw_1924_d
    s_cmp_ge_u32 s60, 8
    s_cbranch_scc1 .Lw_1924_d
    s_sleep 6
    s_branch .Lw_1924
.Lw_1924_d:
    global_load_dwordx4 v[32:35], v[6:7], off
    v_lshl_add_u64 v[6:7], v[6:7], 0, s[30:31]
    global_load_dwordx4 v[36:39], v[6:7], off
    v_lshl_add_u64 v[6:7], v[6:7], 0, s[32:33]
    global_load_dwordx4 v[40:43], v[6:7], off
    v_lshl_add_u64 v[6:7], v[6:7], 0, s[30:31]
    global_load_dwordx4 v[44:47], v[6:7], off
    v_lshl_add_u64 v[6:7], v[6:7], 0, s[32:33]
    global_load_dwordx4 v[48:51], v[6:7], off
    v_lshl_add_u64 v[6:7], v[6:7], 0, s[30:31]
    global_load_dwordx4 v[52:55], v[6:7], off
    v_lshl_add_u64 v[6:7], v[6:7], 0, s[32:33]
    global_load_dwordx4 v[56:59], v[6:7], off
    v_lshl_add_u64 v[6:7], v[6:7], 0, s[30:31]
    global_load_dwordx4 v[60:63], v[6:7], off
    v_lshl_add_u64 v[6:7], v[6:7], 0, v[30:31]
    global_load_dwordx4 v[64:67], v[6:7], off
    s_mov_b32 s92, s46
    s_mov_b32 s93, s47
    s_mov_b32 s94, 5308416
    s_mov_b32 s95, 0x00020000
    s_mov_b32 s12, s48
    s_mov_b32 s13, s49
    s_mov_b32 s14, 2359296
    s_mov_b32 s15, 0x00020000
    v_and_b32 v14, 1, v2
    v_cmp_eq_u32 vcc, 1, v14
    v_mov_b32 v14, 0x0c0c0100
    v_mov_b32 v15, 0x01000c0c
    v_cndmask_b32 v14, v14, v15, vcc
    v_mov_b32 v15, 0x0c0c0302
    v_mov_b32 v20, 0x03020c0c
    v_cndmask_b32 v15, v15, v20, vcc
    v_mov_b32 v20, 0x0c0c0c0c
    v_bfe_u32 v21, v2, 1, 2
    v_cmp_eq_u32 vcc, 0, v21
    s_nop 1
    v_cndmask_b32 v100, v20, v14, vcc
    v_cndmask_b32 v104, v20, v15, vcc
    v_cmp_eq_u32 vcc, 1, v21
    s_nop 1
    v_cndmask_b32 v101, v20, v14, vcc
    v_cndmask_b32 v105, v20, v15, vcc
    v_cmp_eq_u32 vcc, 2, v21
    s_nop 1
    v_cndmask_b32 v102, v20, v14, vcc
    v_cndmask_b32 v106, v20, v15, vcc
    v_cmp_eq_u32 vcc, 3, v21
    s_nop 1
    v_cndmask_b32 v103, v20, v14, vcc
    v_cndmask_b32 v107, v20, v15, vcc
    v_and_b32 v21, 1, v3
    v_cmp_eq_u32 vcc, 1, v21
    s_nop 1
    v_cndmask_b32 v108, v100, v104, vcc
    v_cndmask_b32 v109, v101, v105, vcc
    v_cndmask_b32 v110, v102, v106, vcc
    v_cndmask_b32 v111, v103, v107, vcc
    s_lshl_b32 s21, s18, 9
    s_add_u32 s21, s21, 130560
    v_lshlrev_b32 v6, 8, v4
    v_lshl_add_u32 v6, v9, 5, v6
    v_lshl_add_u32 v6, v21, 4, v6
    v_lshlrev_b32 v7, 4, v9
    v_lshl_add_u32 v7, v21, 7, v7
    v_add_u32 v6, s21, v6
    v_lshlrev_b32 v10, 2, v1
    v_add_u32 v10, 130560, v10
    v_lshlrev_b32 v5, 2, v5
    s_mul_i32 s22, s16, 2304
    s_lshl_b32 s23, s18, 8
    s_add_u32 s22, s22, s23
    s_add_u32 s22, s22, 3866624
    v_lshrrev_b32 v11, 2, v1
    v_mul_u32_u24 v11, 0x900, v11
    v_and_b32 v14, 3, v1
    v_lshl_add_u32 v11, v14, 4, v11
    s_lshl_b32 s23, s16, 4
    s_add_u32 s23, s23, 3866624
    s_lshr_b32 s26, s16, 4
    s_lshl_b32 s26, s26, 7
    s_bfe_u32 s27, s16, 0x10002
    s_lshl_b32 s27, s27, 6
    s_add_u32 s26, s26, s27
    s_bfe_u32 s27, s16, 0x10003
    s_lshl_b32 s27, s27, 3
    s_add_u32 s26, s26, s27
    v_lshl_add_u32 v14, v14, 4, s26
    v_mov_b32 v15, 0
    s_cmp_lg_u32 s18, 1
    s_cbranch_scc1 .Lf_wait
.Lf_poll:
    s_mov_b32 s61, 0
.Lw_2021:
    ds_read_b32 v126, v124 offset:20
    s_add_u32 s61, s61, 1
    s_waitcnt lgkmcnt(0)
    v_readfirstlane_b32 s60, v126
    s_cmp_ge_u32 s61, 4000000
    s_cbranch_scc1 .Lw_2021_d
    s_cmp_ge_u32 s60, 4
    s_cbranch_scc1 .Lw_2021_d
    s_sleep 2
    s_branch .Lw_2021
.Lw_2021_d:
    s_sleep 24
    s_mov_b32 s27, 0
.Lp_k:
    s_add_u32 s37, s34, 0
    buffer_load_dword v16, v12, s[8:11], s37 offen sc1
    s_add_u32 s37, s34, 1024
    buffer_load_dword v17, v12, s[8:11], s37 offen sc1
    s_add_u32 s37, s34, 2048
    buffer_load_dword v18, v12, s[8:11], s37 offen sc1
    s_add_u32 s37, s34, 3072
    buffer_load_dword v19, v12, s[8:11], s37 offen sc1
    s_add_u32 s27, s27, 1
    s_waitcnt vmcnt(0)
    v_min_u32 v20, v16, v17
    v_min3_u32 v20, v20, v18, v19
    v_cmp_eq_u32 vcc, 0, v20
    s_cmp_ge_u32 s27, 100000
    s_cbranch_scc1 .Lp_k_done
    s_nop 2
    s_cbranch_vccz .Lp_k_done
    s_sleep 8
    s_branch .Lp_k
.Lp_k_done:
    v_max_u32 v16, v16, v17
    v_max3_u32 v16, v16, v18, v19
    s_nop 1
    v_max_u32_dpp v16, v16, v16 row_shr:1 row_mask:0xf bank_mask:0xf
    s_nop 1
    v_max_u32_dpp v16, v16, v16 row_shr:2 row_mask:0xf bank_mask:0xf
    s_nop 1
    v_max_u32_dpp v16, v16, v16 row_shr:4 row_mask:0xf bank_mask:0xf
    s_nop 1
    v_max_u32_dpp v16, v16, v16 row_shr:8 row_mask:0xf bank_mask:0xf
    s_nop 1
    v_max_u32_dpp v16, v16, v16 row_bcast:15 row_mask:0xa bank_mask:0xf
    s_nop 1
    v_max_u32_dpp v16, v16, v16 row_bcast:31 row_mask:0xc bank_mask:0xf
    s_nop 0
    v_readlane_b32 s28, v16, 63
    s_nop 0
    s_and_b32 s29, s28, 63
    s_lshl_b32 s29, s29, 2
    s_bfe_u32 s27, s28, 0x20009
    s_add_u32 s29, s29, s27
    s_mul_i32 s29, s29, 2560
    s_add_u32 s29, s29, 3211264
    s_mov_b32 s27, 0
    v_lshlrev_b32 v12, 4, v1
    v_lshlrev_b32 v27, 1, v1
    v_and_b32 v27, 0x7c, v27
.Lf_row:
    buffer_load_dwordx4 v[22:25], v12, s[8:11], s29 offen sc1
    buffer_load_dword v26, v27, s[8:11], s29 offen offset:1024 sc1
    s_add_u32 s27, s27, 1
    s_waitcnt vmcnt(0)
    v_max3_u32 v16, v22, v23, v24
    v_max3_u32 v16, v16, v25, v26
    v_cmp_eq_u32 vcc, -1, v16
    s_cmp_ge_u32 s27, 100000
    s_cbranch_scc1 .Lf_row_done
    s_nop 2
    s_cbranch_vccnz .Lf_row
.Lf_row_done:
    v_add_u32 v12, 134656, v12
    v_add_u32 v27, 135680, v27
    ds_write_b128 v12, v[22:25]
    ds_write_b32 v27, v26
    s_mov_b64 exec, 1
    ds_add_u32 v124, v125 offset:24
    s_mov_b64 exec, -1
.Lf_wait:
    s_mov_b32 s61, 0
.Lw_2090:
    ds_read_b32 v126, v124 offset:20
    s_add_u32 s61, s61, 1
    s_waitcnt lgkmcnt(0)
    v_readfirstlane_b32 s60, v126
    s_cmp_ge_u32 s61, 4000000
    s_cbranch_scc1 .Lw_2090_d
    s_cmp_ge_u32 s60, 4
    s_cbranch_scc1 .Lw_2090_d
    s_sleep 4
    s_branch .Lw_2090
.Lw_2090_d:
    s_mov_b32 s61, 0
.Lw_2101:
    ds_read_b32 v126, v124 offset:24
    s_add_u32 s61, s61, 1
    s_waitcnt lgkmcnt(0)
    v_readfirstlane_b32 s60, v126
    s_cmp_ge_u32 s61, 4000000
    s_cbranch_scc1 .Lw_2101_d
    s_cmp_ge_u32 s60, 1
    s_cbranch_scc1 .Lw_2101_d
    s_sleep 1
    s_branch .Lw_2101
.Lw_2101_d:
    ds_read2_b32 v[22:23], v28 offset0:0 offset1:8
    ds_read2_b32 v[24:25], v28 offset0:16 offset1:24
    ds_read_b32 v26, v29
    s_waitcnt vmcnt(0)
    buffer_load_dwordx4 v[68:71], v8, s[92:95], 0 offen
    buffer_load_dwordx4 v[72:75], v8, s[92:95], s30 offen
    buffer_load_dwordx4 v[76:79], v8, s[92:95], s35 offen
    buffer_load_dwordx4 v[80:83], v8, s[92:95], s36 offen
    s_cmp_lg_u32 s18, 0
    s_cbranch_scc1 .Lf_1
    buffer_load_dwordx4 v[84:87], v8, s[92:95], 0 offen offset:1024
    buffer_load_dwordx4 v[88:91], v8, s[92:95], s30 offen offset:1024
    buffer_load_dwordx4 v[92:95], v8, s[92:95], s35 offen offset:1024
    buffer_load_dwordx4 v[96:99], v8, s[92:95], s36 offen offset:1024
.Lf_1:
    s_waitcnt lgkmcnt(0)
    v_perm_b32 v16, v22, v22, v100
    v_perm_b32 v17, v22, v22, v101
    v_perm_b32 v18, v22, v22, v102
    v_perm_b32 v19, v22, v22, v103
    s_nop 1
    v_mfma_f32_16x16x32_bf16 v[116:119], v[16:19], v[32:35], 0
    v_perm_b32 v112, v22, v22, v104
    v_perm_b32 v113, v22, v22, v105
    v_perm_b32 v114, v22, v22, v106
    v_perm_b32 v115, v22, v22, v107
    s_nop 1
    v_mfma_f32_16x16x32_bf16 v[116:119], v[112:115], v[36:39], v[116:119]
    v_perm_b32 v16, v23, v23, v100
    v_perm_b32 v17, v23, v23, v101
    v_perm_b32 v18, v23, v23, v102
    v_perm_b32 v19, v23, v23, v103
    s_nop 1
    v_mfma_f32_16x16x32_bf16 v[116:119], v[16:19], v[40:43], v[116:119]
    v_perm_b32 v112, v23, v23, v104
    v_perm_b32 v113, v23, v23, v105
    v_perm_b32 v114, v23, v23, v106
    v_perm_b32 v115, v23, v23, v107
    s_nop 1
    v_mfma_f32_16x16x32_bf16 v[116:119], v[112:115], v[44:47], v[116:119]
    v_perm_b32 v16, v24, v24, v100
    v_perm_b32 v17, v24, v24, v101
    v_perm_b32 v18, v24, v24, v102
    v_perm_b32 v19, v24, v24, v103
    s_nop 1
    v_mfma_f32_16x16x32_bf16 v[116:119], v[16:19], v[48:51], v[116:119]
    v_perm_b32 v112, v24, v24, v104
    v_perm_b32 v113, v24, v24, v105
    v_perm_b32 v114, v24, v24, v106
    v_perm_b32 v115, v24, v24, v107
    s_nop 1
    v_mfma_f32_16x16x32_bf16 v[116:119], v[112:115], v[52:55], v[116:119]
    v_perm_b32 v16, v25, v25, v100
    v_perm_b32 v17, v25, v25, v101
    v_perm_b32 v18, v25, v25, v102
    v_perm_b32 v19, v25, v25, v103
    s_nop 1
    v_mfma_f32_16x16x32_bf16 v[116:119], v[16:19], v[56:59], v[116:119]
    v_perm_b32 v112, v25, v25, v104
    v_perm_b32 v113, v25, v25, v105
    v_perm_b32 v114, v25, v25, v106
    v_perm_b32 v115, v25, v25, v107
    s_nop 1
    v_mfma_f32_16x16x32_bf16 v[116:119], v[112:115], v[60:63], v[116:119]
    v_perm_b32 v16, v26, v26, v108
    v_perm_b32 v17, v26, v26, v109
    v_perm_b32 v18, v26, v26, v110
    v_perm_b32 v19, v26, v26, v111
    s_nop 1
    v_mfma_f32_16x16x32_bf16 v[116:119], v[16:19], v[64:67], v[116:119]
    s_mov_b32 exec_lo, 0x00ff00ff
    s_mov_b32 exec_hi, 0xff00ff00
    s_nop 5
    ds_write_b128 v6, v[116:119]
    s_mov_b64 exec, 1
    ds_add_u32 v124, v125 offset:28
    s_mov_b64 exec, -1
    s_mov_b32 s61, 0
.Lw_2178:
    ds_read_b32 v126, v124 offset:28
    s_add_u32 s61, s61, 1
    s_waitcnt lgkmcnt(0)
    v_readfirstlane_b32 s60, v126
    s_cmp_ge_u32 s61, 4000000
    s_cbranch_scc1 .Lw_2178_d
    s_cmp_ge_u32 s60, 8
    s_cbranch_scc0 .Lw_2178
.Lw_2178_d:
    ds_read2st64_b32 v[32:33], v10 offset0:0 offset1:1
    ds_read2st64_b32 v[34:35], v10 offset0:2 offset1:3
    ds_read2st64_b32 v[36:37], v10 offset0:4 offset1:5
    ds_read2st64_b32 v[38:39], v10 offset0:6 offset1:7
    ds_read2st64_b32 v[40:41], v10 offset0:8 offset1:9
    ds_read2st64_b32 v[42:43], v10 offset0:10 offset1:11
    ds_read2st64_b32 v[44:45], v10 offset0:12 offset1:13
    ds_read2st64_b32 v[46:47], v10 offset0:14 offset1:15
    s_waitcnt lgkmcnt(0)
    v_pk_add_f32 v[32:33], v[32:33], v[40:41]
    v_pk_add_f32 v[34:35], v[34:35], v[42:43]
    v_pk_add_f32 v[36:37], v[36:37], v[44:45]
    v_pk_add_f32 v[38:39], v[38:39], v[46:47]
    v_pk_add_f32 v[32:33], v[32:33], v[36:37]
    v_pk_add_f32 v[34:35], v[34:35], v[38:39]
    v_pk_add_f32 v[32:33], v[32:33], v[34:35]
    v_add_f32 v32, v32, v33
    v_cvt_pk_bf16_f32 v32, v32, v32
    v_lshlrev_b32 v32, 16, v32
    v_mul_f32 v33, 0xbfb8aa3b, v32
    v_exp_f32 v33, v33
    v_mov_b32 v34, v32
    v_add_f32 v33, 1.0, v33
    v_rcp_f32 v33, v33
    v_mov_b32 v35, v32
    v_mul_f32 v33, v33, v32
    s_nop 0
    v_permlane32_swap_b32 v34, v35
    v_cvt_pk_bf16_f32 v33, v33, v33
    v_lshlrev_b32 v33, 16, v33
    v_mul_f32 v33, v33, v35
    v_cvt_pk_bf16_f32 v33, v33, v33
    ds_bpermute_b32 v22, v5, v33 offset:0
    ds_bpermute_b32 v23, v5, v33 offset:32
    ds_bpermute_b32 v24, v5, v33 offset:64
    ds_bpermute_b32 v25, v5, v33 offset:96
    s_waitcnt vmcnt(0)
    s_waitcnt lgkmcnt(3)
    v_perm_b32 v36, v22, v22, v100
    v_perm_b32 v37, v22, v22, v101
    v_perm_b32 v38, v22, v22, v102
    v_perm_b32 v39, v22, v22, v103
    s_nop 1
    v_mfma_f32_16x16x32_bf16 v[116:119], v[36:39], v[68:71], 0
    s_waitcnt lgkmcnt(2)
    v_perm_b32 v40, v23, v23, v100
    v_perm_b32 v41, v23, v23, v101
    v_perm_b32 v42, v23, v23, v102
    v_perm_b32 v43, v23, v23, v103
    s_nop 1
    v_mfma_f32_16x16x32_bf16 v[116:119], v[40:43], v[72:75], v[116:119]
    s_waitcnt lgkmcnt(1)
    v_perm_b32 v44, v24, v24, v100
    v_perm_b32 v45, v24, v24, v101
    v_perm_b32 v46, v24, v24, v102
    v_perm_b32 v47, v24, v24, v103
    s_nop 1
    v_mfma_f32_16x16x32_bf16 v[116:119], v[44:47], v[76:79], v[116:119]
    s_waitcnt lgkmcnt(0)
    v_perm_b32 v48, v25, v25, v100
    v_perm_b32 v49, v25, v25, v101
    v_perm_b32 v50, v25, v25, v102
    v_perm_b32 v51, v25, v25, v103
    s_nop 1
    v_mfma_f32_16x16x32_bf16 v[116:119], v[48:51], v[80:83], v[116:119]
    s_cmp_lg_u32 s18, 0
    s_cbranch_scc1 .Lf_2
    v_mfma_f32_16x16x32_bf16 v[120:123], v[36:39], v[84:87], 0
    v_mfma_f32_16x16x32_bf16 v[120:123], v[40:43], v[88:91], v[120:123]
    v_mfma_f32_16x16x32_bf16 v[120:123], v[44:47], v[92:95], v[120:123]
    v_mfma_f32_16x16x32_bf16 v[120:123], v[48:51], v[96:99], v[120:123]
    s_nop 7
    v_permlane32_swap_b32 v120, v122
    v_permlane32_swap_b32 v121, v123
    s_nop 0
    v_add_f32_dpp v120, v122, v120 row_ror:8 row_mask:0xf bank_mask:0xf
    v_add_f32_dpp v121, v123, v121 row_ror:8 row_mask:0xf bank_mask:0xf
    v_min_u32 v120, -2, v120
    v_min_u32 v121, -2, v121
    s_nop 0
    v_permlane32_swap_b32 v120, v122
    v_permlane32_swap_b32 v121, v123
    s_mov_b64 exec, 0x00ff00ff
    buffer_store_dwordx4 v[120:123], v7, s[8:11], s22 offen offset:2048 sc1
    s_mov_b64 exec, -1
.Lf_2:
    s_nop 7
    v_permlane32_swap_b32 v116, v118
    v_permlane32_swap_b32 v117, v119
    s_nop 0
    v_add_f32_dpp v116, v118, v116 row_ror:8 row_mask:0xf bank_mask:0xf
    v_add_f32_dpp v117, v119, v117 row_ror:8 row_mask:0xf bank_mask:0xf
    v_min_u32 v116, -2, v116
    v_min_u32 v117, -2, v117
    s_nop 0
    v_permlane32_swap_b32 v116, v118
    v_permlane32_swap_b32 v117, v119
    s_mov_b64 exec, 0x00ff00ff
    buffer_store_dwordx4 v[116:119], v7, s[8:11], s22 offen offset:0 sc1
    s_mov_b64 exec, -1
    s_cmp_lg_u32 s18, 1
    s_cbranch_scc1 .Lend
    s_and_b32 s27, s16, 3
    s_cmp_lg_u32 s27, 0
    s_cbranch_scc1 .Lf_fin
    s_sleep 18
.Lf_rp:
    s_mov_b32 s24, s23
    buffer_load_dwordx4 v[52:55], v11, s[8:11], s24 offen sc1
    s_add_u32 s24, s24, 36864
    buffer_load_dwordx4 v[56:59], v11, s[8:11], s24 offen sc1
    s_add_u32 s24, s24, 36864
    buffer_load_dwordx4 v[60:63], v11, s[8:11], s24 offen sc1
    s_add_u32 s24, s24, 36864
    buffer_load_dwordx4 v[64:67], v11, s[8:11], s24 offen sc1
    s_add_u32 s24, s24, 36864
    buffer_load_dwordx4 v[68:71], v11, s[8:11], s24 offen sc1
    s_add_u32 s24, s24, 36864
    buffer_load_dwordx4 v[72:75], v11, s[8:11], s24 offen sc1
    s_add_u32 s24, s24, 36864
    buffer_load_dwordx4 v[76:79], v11, s[8:11], s24 offen sc1
    s_add_u32 s24, s24, 36864
    buffer_load_dwordx4 v[80:83], v11, s[8:11], s24 offen sc1
    s_add_u32 s24, s24, 36864
    buffer_load_dwordx4 v[84:87], v11, s[8:11], s24 offen sc1
    buffer_load_dwordx2 v[44:45], v14, s[8:11], s29 offen sc1
    buffer_load_dwordx2 v[46:47], v14, s[8:11], s29 offen offset:1152 sc1
    buffer_load_dword v48, v15, s[8:11], s29 offen offset:2304 sc1
    s_add_u32 s27, s27, 1
    s_waitcnt vmcnt(11)
    v_max3_u32 v16, v52, v53, v54
    v_max_u32 v16, v16, v55
    s_waitcnt vmcnt(10)
    v_max3_u32 v16, v16, v56, v57
    v_max3_u32 v16, v16, v58, v59
    v_pk_add_f32 v[32:33], v[52:53], v[56:57]
    v_pk_add_f32 v[34:35], v[54:55], v[58:59]
    s_waitcnt vmcnt(9)
    v_max3_u32 v16, v16, v60, v61
    v_max3_u32 v16, v16, v62, v63
    v_pk_add_f32 v[32:33], v[32:33], v[60:61]
    v_pk_add_f32 v[34:35], v[34:35], v[62:63]
    s_waitcnt vmcnt(8)
    v_max3_u32 v16, v16, v64, v65
    v_max3_u32 v16, v16, v66, v67
    v_pk_add_f32 v[32:33], v[32:33], v[64:65]
    v_pk_add_f32 v[34:35], v[34:35], v[66:67]
    s_waitcnt vmcnt(7)
    v_max3_u32 v16, v16, v68, v69
    v_max3_u32 v16, v16, v70, v71
    v_pk_add_f32 v[32:33], v[32:33], v[68:69]
    v_pk_add_f32 v[34:35], v[34:35], v[70:71]
    s_waitcnt vmcnt(6)
    v_max3_u32 v16, v16, v72, v73
    v_max3_u32 v16, v16, v74, v75
    v_pk_add_f32 v[32:33], v[32:33], v[72:73]
    v_pk_add_f32 v[34:35], v[34:35], v[74:75]
    s_waitcnt vmcnt(5)
    v_max3_u32 v16, v16, v76, v77
    v_max3_u32 v16, v16, v78, v79
    v_pk_add_f32 v[32:33], v[32:33], v[76:77]
    v_pk_add_f32 v[34:35], v[34:35], v[78:79]
    s_waitcnt vmcnt(4)
    v_max3_u32 v16, v16, v80, v81
    v_max3_u32 v16, v16, v82, v83
    v_pk_add_f32 v[32:33], v[32:33], v[80:81]
    v_pk_add_f32 v[34:35], v[34:35], v[82:83]
    s_waitcnt vmcnt(3)
    v_max3_u32 v16, v16, v84, v85
    v_max3_u32 v16, v16, v86, v87
    v_pk_add_f32 v[32:33], v[32:33], v[84:85]
    v_pk_add_f32 v[34:35], v[34:35], v[86:87]
    s_waitcnt vmcnt(0)
    v_max3_u32 v16, v16, v44, v45
    v_max3_u32 v17, v46, v47, v48
    v_max_u32 v16, v16, v17
    v_cmp_eq_u32 vcc, -1, v16
    s_cmp_ge_u32 s27, 100000
    s_cbranch_scc1 .Lf_rp_done
    s_nop 2
    s_cbranch_vccz .Lf_rp_done
    s_sleep 4
    s_branch .Lf_rp
.Lf_rp_done:
    v_cvt_pk_bf16_f32 v48, v48, v48
    v_lshlrev_b32 v48, 16, v48
    v_mul_f32 v48, 0xbfb8aa3b, v48
    v_add_f32_dpp v32, v32, v32 row_ror:4 row_mask:0xf bank_mask:0xf
    v_add_f32_dpp v33, v33, v33 row_ror:4 row_mask:0xf bank_mask:0xf
    v_add_f32_dpp v34, v34, v34 row_ror:4 row_mask:0xf bank_mask:0xf
    v_add_f32_dpp v35, v35, v35 row_ror:4 row_mask:0xf bank_mask:0xf
    v_add_f32_dpp v32, v32, v32 row_ror:8 row_mask:0xf bank_mask:0xf
    v_add_f32_dpp v33, v33, v33 row_ror:8 row_mask:0xf bank_mask:0xf
    v_add_f32_dpp v34, v34, v34 row_ror:8 row_mask:0xf bank_mask:0xf
    v_add_f32_dpp v35, v35, v35 row_ror:8 row_mask:0xf bank_mask:0xf
    v_exp_f32 v48, v48
    v_mov_b32 v36, v32
    v_mov_b32 v37, v33
    v_mov_b32 v38, v34
    v_mov_b32 v39, v35
    v_permlane16_swap_b32 v32, v36
    v_permlane16_swap_b32 v33, v37
    v_permlane16_swap_b32 v34, v38
    v_permlane16_swap_b32 v35, v39
    v_add_f32 v32, v32, v36
    v_add_f32 v33, v33, v37
    v_add_f32 v34, v34, v38
    v_add_f32 v35, v35, v39
    v_mov_b32 v36, v32
    v_mov_b32 v37, v33
    v_mov_b32 v38, v34
    v_mov_b32 v39, v35
    v_permlane32_swap_b32 v32, v36
    v_permlane32_swap_b32 v33, v37
    v_permlane32_swap_b32 v34, v38
    v_permlane32_swap_b32 v35, v39
    v_add_f32 v32, v32, v36
    v_add_f32 v33, v33, v37
    v_add_f32 v34, v34, v38
    v_add_f32 v35, v35, v39
    v_add_f32 v48, 1.0, v48
    v_rcp_f32 v48, v48
    v_cvt_pk_bf16_f32 v50, v32, v33
    v_cvt_pk_bf16_f32 v51, v34, v35
    v_lshlrev_b32 v32, 16, v50
    v_and_b32 v33, 0xffff0000, v50
    v_lshlrev_b32 v34, 16, v51
    v_and_b32 v35, 0xffff0000, v51
    v_cvt_pk_bf16_f32 v48, v48, v48
    v_lshlrev_b32 v48, 16, v48
    v_mul_f32 v32, v32, v48
    v_mul_f32 v33, v33, v48
    v_mul_f32 v34, v34, v48
    v_mul_f32 v35, v35, v48
    v_cvt_pk_bf16_f32 v50, v32, v33
    v_cvt_pk_bf16_f32 v51, v34, v35
    v_lshlrev_b32 v32, 16, v50
    v_and_b32 v33, 0xffff0000, v50
    v_lshlrev_b32 v34, 16, v51
    v_and_b32 v35, 0xffff0000, v51
    s_mov_b32 s52, 0x00003f80
    s_mov_b32 s53, 0x3f800000
    v_dot2_f32_bf16 v32, v44, s52, v32
    v_dot2_f32_bf16 v33, v44, s53, v33
    v_dot2_f32_bf16 v34, v45, s52, v34
    v_dot2_f32_bf16 v35, v45, s53, v35
    s_nop 0
    v_cvt_pk_bf16_f32 v50, v32, v33
    s_nop 0
    v_cvt_pk_bf16_f32 v51, v34, v35
    v_lshlrev_b32 v32, 16, v50
    v_and_b32 v33, 0xffff0000, v50
    v_lshlrev_b32 v34, 16, v51
    v_and_b32 v35, 0xffff0000, v51
    v_dot2_f32_bf16 v32, v46, s52, v32
    v_dot2_f32_bf16 v33, v46, s53, v33
    v_dot2_f32_bf16 v34, v47, s52, v34
    v_dot2_f32_bf16 v35, v47, s53, v35
    s_nop 0
    v_cvt_pk_bf16_f32 v50, v32, v33
    s_nop 0
    v_cvt_pk_bf16_f32 v51, v34, v35
    s_and_b32 s28, s28, 0x7ff
    s_mul_i32 s28, s28, 1152
    s_mov_b64 exec, 15
    buffer_store_dwordx2 v[50:51], v14, s[12:15], s28 offen
.Lf_fin:
.Lend:
    s_endpgm
.p2align 6
.Ltext_end:

.section .rodata,"a"
.p2align 6
.amdhsa_kernel sequential_preLN__spectral_fnet__moe_arch_mod__prompt_kernel
  .amdhsa_next_free_vgpr 128
  .amdhsa_next_free_sgpr 96
  .amdhsa_accum_offset 128
  .amdhsa_group_segment_fixed_size 0
  .amdhsa_kernarg_size 104
  .amdhsa_user_sgpr_count 2
  .amdhsa_user_sgpr_kernarg_segment_ptr 1
  .amdhsa_system_sgpr_workgroup_id_x 1
.end_amdhsa_kernel
```
